```python
import torch

def _softmax(x, axis=-1):
    return torch.softmax(x, dim=axis)
def _gelu(x):
    return torch.nn.functional.gelu(x, approximate="tanh")
def _silu(x):
    return torch.nn.functional.silu(x)
def _sigmoid(x):
    return torch.sigmoid(x)
def _layernorm(x, axis=-1, eps=1e-5):
    m = x.mean(dim=axis, keepdim=True)
    v = x.var(dim=axis, keepdim=True, unbiased=False)
    return (x - m) / torch.sqrt(v + eps)
def _scatter_add(tgt, idx, src, axis=0):
    return tgt.clone().index_add_(axis, idx, src)
def _segment_sum(src, seg, n):
    out = torch.zeros((n,) + src.shape[1:], dtype=src.dtype)
    return out.index_add_(0, seg, src)
def _pad(x, pw):
    flat = tuple(v for pair in reversed(pw) for v in pair)
    return torch.nn.functional.pad(x, flat)

kernel_name = 'interleave_layers__sliding_block_cached__glu_gated_reglu__decode'

def setup_inputs():

    _w = (lambda a: (lambda t: t.to(torch.bfloat16) if t.is_floating_point() else t)(torch.as_tensor(a)))
    def _A_setup():
        B, Sq, D = 4, 1, 640
        Hq, Hkv, Sk, Dh = 32, 32, 4096, 128
        assert Hq % Hkv == 0, (Hq, Hkv)
        return {
            "x": _w((lambda *s: torch.randn(*s, dtype=torch.bfloat16) * 0.05)(B, Sq, D)),
            "k_cache": _w((lambda *s: torch.randn(*s, dtype=torch.bfloat16) * 0.8)(B, Hkv, Sk, Dh)),
            "v_cache": _w((lambda *s: torch.randn(*s, dtype=torch.bfloat16) * 0.8)(B, Hkv, Sk, Dh)),
            "wq": _w((lambda *s: torch.randn(*s, dtype=torch.bfloat16) * 0.8)(D, Hq * Dh) * (D ** -0.5)),
            "wo": _w((lambda *s: torch.randn(*s, dtype=torch.bfloat16) * 0.8)(Hq * Dh, D) * ((Hq * Dh) ** -0.5)),
        }
    _A_in = _A_setup()

    def _B_setup():
        B, S, D, F = 4, 1, 640, 1728
        return {
            "x": _w((lambda *s: torch.randn(*s, dtype=torch.bfloat16) * 0.05)(B, S, D)),
            "W_gate": _w((lambda *s: torch.randn(*s, dtype=torch.bfloat16) * 0.2)(D, F) * (2.0 / D) ** 0.5),
            "W_up": _w((lambda *s: torch.randn(*s, dtype=torch.bfloat16) * 0.2)(D, F) * (2.0 / D) ** 0.5),
            "W_down": _w((lambda *s: torch.randn(*s, dtype=torch.bfloat16) * 0.2)(F, D) * (1.0 / F) ** 0.5),
        }
    _B_in = _B_setup()

    return {
        "A_x": _A_in["x"],
        "A_k_cache": _A_in["k_cache"],
        "A_v_cache": _A_in["v_cache"],
        "A_wq": _A_in["wq"],
        "A_wo": _A_in["wo"],
        "B_x": _B_in["x"],
        "B_W_gate": _B_in["W_gate"],
        "B_W_up": _B_in["W_up"],
        "B_W_down": _B_in["W_down"],
    }

def reference(A_x, A_k_cache, A_v_cache, A_wq, A_wo, B_x, B_W_gate, B_W_up, B_W_down):
    def _A_ref(x, k_cache, v_cache, wq, wo):
        B, Sq, D = x.shape
        Hq, Dh = 32, 128
        Hkv, Sk = k_cache.shape[1], k_cache.shape[2]
        W = min(4096, max(256, Sk // 4))
        rep = Hq // Hkv
        q = (lambda x, *d: x.permute(*d))((x @ wq).reshape(B, Sq, Hq, Dh), 0, 2, 1, 3)
        k = (lambda x, n, axis: torch.repeat_interleave(x, n, dim=axis))(k_cache[:, :, Sk - W:, :], rep, axis=1)
        v = (lambda x, n, axis: torch.repeat_interleave(x, n, dim=axis))(v_cache[:, :, Sk - W:, :], rep, axis=1)
        scores = torch.einsum("bhqd,bhkd->bhqk", q, k) * (Dh ** -0.5)
        p = _softmax(scores, axis=-1)
        o = torch.einsum("bhqk,bhkd->bhqd", p, v)
        return (lambda x, *d: x.permute(*d))(o, 0, 2, 1, 3).reshape(B, Sq, Hq * Dh) @ wo

    def _B_ref(x, W_gate, W_up, W_down):
        gate = torch.einsum("bsd,df->bsf", x, W_gate)
        up = torch.einsum("bsd,df->bsf", x, W_up)
        gate = gate * (lambda x, dt: x.to(dt))(gate > 0, gate.dtype)
        h = gate * up
        return torch.einsum("bsf,fd->bsd", h, W_down)

    x = A_x
    x = x + _A_ref(_layernorm(x, axis=-1), A_k_cache, A_v_cache, A_wq, A_wo)
    x = x + _B_ref(_layernorm(x, axis=-1), B_W_gate, B_W_up, B_W_down)
    x = x + _A_ref(_layernorm(x, axis=-1), A_k_cache, A_v_cache, A_wq, A_wo)
    x = x + _B_ref(_layernorm(x, axis=-1), B_W_gate, B_W_up, B_W_down)
    return x
```

```asm
; @launch grid=(256,1,1) block=(512,1,1) lds=122880
.amdgcn_target "amdgcn-amd-amdhsa--gfx950"
.text
.globl interleave_layers__sliding_block_cached__glu_gated_reglu__decode_kernel
.p2align 12
.p2align 8
.type interleave_layers__sliding_block_cached__glu_gated_reglu__decode_kernel,@function
interleave_layers__sliding_block_cached__glu_gated_reglu__decode_kernel:
    s_cmp_ge_u32 s2, 256
    s_cbranch_scc1 L_END
    s_load_dwordx16 s[8:23], s[0:1], 0
    s_load_dwordx8 s[24:31], s[0:1], 64
    s_getpc_b64 s[36:37]
L_PC:
    s_and_b32 s38, s2, 0xf8
    s_mul_i32 s38, s38, 96
    v_min_u32 v1, 5, v0
    v_lshl_add_u32 v1, v1, 7, s38
    v_min_u32 v1, L_END-L_PC, v1
    global_load_dword v56, v1, s[36:37]
    s_mov_b32 s6, 0
    v_lshrrev_b32 v1, 6, v0
    v_and_b32 v0, 63, v0
    v_readfirstlane_b32 s3, v1
    s_and_b32 s4, s2, 7
    s_lshr_b32 s5, s2, 3
    s_lshr_b32 s38, s5, 3
    s_add_u32 s55, s4, s38
    s_and_b32 s55, s55, 7
    s_and_b32 s38, s5, 24
    s_add_u32 s55, s55, s38
    s_bfe_u32 s57, s5, 0x20001
    s_and_b32 s39, s5, 1
    s_lshl_b32 s49, s57, 25
    s_lshl_b32 s50, s55, 20
    s_add_u32 s49, s49, s50
    s_lshl_b32 s50, s39, 17
    s_add_u32 s49, s49, s50
    s_add_u32 s49, s49, 786432
    s_lshl_b32 s98, s3, 11
    s_lshl_b32 s50, s5, 14
    s_add_u32 s98, s98, s50
    s_mul_i32 s50, s4, 49152
    s_add_u32 s98, s98, s50
    s_and_b32 s98, s98, 0x1ffff
    s_add_u32 s39, s49, s98
    v_bfe_u32 v58, v0, 1, 3
    v_lshlrev_b32 v58, 8, v58
    v_and_b32 v60, 1, v0
    v_lshl_add_u32 v58, v60, 6, v58
    v_lshrrev_b32 v60, 4, v0
    v_lshl_add_u32 v58, v60, 4, v58
    s_lshl_b32 s38, s5, 3
    s_add_u32 s38, s38, s3
    s_waitcnt lgkmcnt(0)
    s_add_u32 s32, s10, s39
    s_addc_u32 s33, s11, 0
    s_cmp_eq_u32 s38, 1
    s_cbranch_scc1 L_LEAD
L_PRO_L:
    global_load_dwordx4 v[128:131], v58, s[32:33] offset:0 nt
    global_load_dwordx4 v[132:135], v58, s[32:33] offset:128 nt
    s_add_u32 s10, s10, s49
    s_addc_u32 s11, s11, 0
    s_add_u32 s12, s12, s49
    s_addc_u32 s13, s13, 0
    s_add_u32 s98, s98, 16384
    s_and_b32 s98, s98, 0x1ffff
    s_add_u32 s32, s10, s98
    s_addc_u32 s33, s11, 0
    global_load_dwordx4 v[136:139], v58, s[32:33] offset:0 nt
    global_load_dwordx4 v[140:143], v58, s[32:33] offset:128 nt
    v_lshlrev_b32 v2, 4, v0
    s_cmp_lg_u32 s3, 2
    s_cselect_b64 vcc, 0, -1
    s_cmp_ge_u32 s3, 4
    s_cbranch_scc1 L_PRO_X
    s_lshl_b32 s56, s5, 1
    s_add_u32 s56, s56, s3
    s_cmp_eq_u32 s3, 3
    s_cbranch_scc1 L_PRO_X3
    s_cmp_eq_u32 s3, 2
    s_cbranch_scc1 L_PRO_X2
    s_min_u32 s39, s56, 39
    s_lshl_b32 s38, s39, 5
    v_bfe_u32 v60, v0, 2, 2
    v_mul_u32_u24 v60, 1280, v60
    v_and_b32 v61, 3, v0
    v_lshl_add_u32 v60, v61, 3, v60
    v_lshrrev_b32 v61, 5, v0
    v_lshl_add_u32 v60, v61, 2, v60
    v_add_u32 v60, s38, v60
    global_load_dword v14, v60, s[8:9]
    s_branch L_PRO_A
L_PRO_X2:
    v_mov_b32 v124, -1
    v_mov_b32 v125, -1
    v_mov_b32 v126, -1
    v_mov_b32 v127, -1
    s_mul_i32 s38, s4, 36864
    s_mul_i32 s50, s5, 1152
    s_add_u32 s38, s38, s50
    v_lshl_add_u32 v60, v0, 4, s38
    global_store_dwordx4 v60, v[124:127], s[30:31]
    s_mov_b64 exec, 0xff
    global_store_dwordx4 v60, v[124:127], s[30:31] offset:1024
    s_mov_b64 exec, -1
    s_mul_i32 s38, s4, 81920
    s_mul_i32 s50, s5, 2560
    s_add_u32 s38, s38, s50
    s_add_u32 s38, s38, 294912
    v_lshl_add_u32 v60, v0, 4, s38
    global_store_dwordx4 v60, v[124:127], s[30:31]
    global_store_dwordx4 v60, v[124:127], s[30:31] offset:1024
    s_mov_b32 exec_hi, 0
    global_store_dwordx4 v60, v[124:127], s[30:31] offset:2048
    s_mov_b64 exec, -1
    s_cmp_ge_u32 s5, 20
    s_cbranch_scc1 L_PRO_C
    s_lshr_b32 s39, s5, 1
    s_and_b32 s49, s5, 1
    s_lshl_b32 s38, s39, 14
    s_lshl_b32 s50, s49, 12
    s_add_u32 s38, s38, s50
    s_lshl_b32 s50, s4, 8
    s_add_u32 s38, s38, s50
    s_add_u32 s38, s38, 966656
    v_lshrrev_b32 v60, 5, v0
    v_lshlrev_b32 v60, 13, v60
    v_bfe_u32 v61, v0, 4, 1
    v_lshl_add_u32 v60, v61, 11, v60
    v_and_b32 v61, 15, v0
    v_lshl_add_u32 v60, v61, 4, v60
    v_add_u32 v60, s38, v60
    global_store_dwordx4 v60, v[124:127], s[30:31] sc1
    v_add_u32 v60, 163840, v60
    global_store_dwordx4 v60, v[124:127], s[30:31] sc1
L_PRO_C:
    v_mov_b32 v44, 0
    v_mov_b32 v45, 0
    v_mov_b32 v46, 0
    v_mov_b32 v47, 0
    v_lshlrev_b32 v62, 2, v0
    v_add_u32 v62, 116992, v62
    ds_write_b32 v62, v124
    v_lshlrev_b32 v62, 2, v0
    v_add_u32 v62, 122624, v62
    ds_write_b32 v62, v124
    v_add_u32 v62, 118528, v2
    ds_write_b128 v62, v[124:127]
    ds_write_b128 v62, v[124:127] offset:1024
    ds_write_b128 v62, v[124:127] offset:2048
    ds_write_b128 v62, v[124:127] offset:3072
    v_add_u32 v62, 68352, v2
    s_cmp_ge_u32 s5, 20
    s_cbranch_scc1 L_PRO_A
    ds_write_b128 v62, v[44:47]
    ds_write_b128 v62, v[44:47] offset:1024
    ds_write_b128 v62, v[44:47] offset:2176
    ds_write_b128 v62, v[44:47] offset:3200
    s_branch L_PRO_A
L_LEAD:
    v_mov_b32 v124, -1
    v_mov_b32 v125, -1
    v_mov_b32 v126, -1
    v_mov_b32 v127, -1
    s_lshl_b32 s38, s4, 9
    s_add_u32 s38, s38, 950272
    v_lshl_add_u32 v60, v0, 4, s38
    s_lshl_b32 s38, s4, 5
    v_mov_b32 v62, s38
    s_mov_b32 exec_hi, 0
    global_store_dwordx4 v60, v[124:127], s[30:31] sc1
    s_waitcnt vmcnt(0)
    s_mov_b64 exec, 1
    global_store_dword v62, v124, s[28:29] sc1
    s_mov_b64 exec, -1
    s_branch L_PRO_L
L_PRO_X3:
    s_mul_i32 s38, s57, 1280
    v_lshl_add_u32 v60, v0, 2, s38
    global_load_dword v24, v60, s[8:9] offset:0
    global_load_dword v25, v60, s[8:9] offset:256
    global_load_dword v26, v60, s[8:9] offset:512
    global_load_dword v27, v60, s[8:9] offset:768
    global_load_dword v28, v60, s[8:9] offset:1024
    s_branch L_PRO_A
L_PRO_X:
    s_and_b32 s39, s5, 3
    s_mul_i32 s38, s39, 320
    v_bfe_u32 v108, v0, 2, 2
    v_mul_u32_u24 v108, 1280, v108
    v_and_b32 v111, 1, v0
    v_lshl_add_u32 v108, v111, 7, v108
    v_bfe_u32 v111, v0, 1, 1
    v_lshl_add_u32 v108, v111, 6, v108
    v_lshrrev_b32 v111, 4, v0
    v_lshl_add_u32 v108, v111, 4, v108
    v_add_u32 v108, s38, v108
    v_bfe_u32 v109, v0, 2, 2
    v_mul_u32_u24 v109, 1280, v109
    v_lshrrev_b32 v111, 4, v0
    v_lshl_add_u32 v109, v111, 4, v109
    v_add_u32 v109, s38, v109
    global_load_dwordx4 v[88:91], v108, s[8:9]
    global_load_dwordx4 v[92:95], v109, s[8:9] offset:256
L_PRO_A:
    v_lshrrev_b32 v16, 3, v0
    v_lshlrev_b32 v16, 13, v16
    v_and_b32 v61, 7, v0
    v_lshl_add_u32 v16, v61, 4, v16
    s_and_b32 s39, s5, 3
    s_and_b32 s49, s5, 4
    s_mul_i32 s38, s39, 1310720
    s_lshl_b32 s50, s3, 16
    s_add_u32 s38, s38, s50
    s_lshl_b32 s50, s55, 8
    s_add_u32 s38, s38, s50
    s_lshl_b32 s50, s49, 5
    s_add_u32 s38, s38, s50
    s_add_u32 s36, s14, s38
    s_addc_u32 s37, s15, 0
    s_lshl_b32 s39, s3, 10
    s_add_u32 m0, s39, 0
    s_nop 0
    global_load_lds_dwordx4 v16, s[36:37] nt
    s_add_u32 s36, s36, 524288
    s_addc_u32 s37, s37, 0
WQ_1:
    s_lshl_b32 s39, s3, 10
    s_add_u32 m0, s39, 8192
    s_nop 0
    global_load_lds_dwordx4 v16, s[36:37] nt
    s_add_u32 s36, s36, 524288
    s_addc_u32 s37, s37, 0
WQ_2:
    s_cmp_ge_u32 s3, 4
    s_cbranch_scc1 WQ_3
    s_lshl_b32 s39, s3, 10
    s_add_u32 m0, s39, 16384
    s_nop 0
    global_load_lds_dwordx4 v16, s[36:37] nt
WQ_3:
    s_add_u32 s98, s98, 16384
    s_and_b32 s98, s98, 0x1ffff
    s_add_u32 s32, s10, s98
    s_addc_u32 s33, s11, 0
    global_load_dwordx4 v[144:147], v58, s[32:33] offset:0 nt
    s_cbranch_vccnz TS_4
    s_waitcnt vmcnt(3)
TS_4:
    s_mov_b32 s54, 0x3f803f80
    v_bfe_u32 v1, v0, 1, 1
    v_mul_u32_u24 v1, 0xaaaa, v1
    v_add_u32 v1, 0x4444, v1
    s_mov_b32 s40, 0x3e0293ee
    s_mov_b32 s41, 0x05040100
    s_mov_b32 s42, 0x07060302
    s_mov_b32 s58, 0xaaaaaaaa
    s_mov_b32 s59, 0xaaaaaaaa
    s_mov_b32 s96, 0x00ff00ff
    s_mov_b32 s97, 0x00ff00ff
    s_mov_b32 s52, 0x11111111
    s_mov_b32 s53, 0x11111111
    s_cmp_eq_u32 s3, 0
    s_cselect_b32 s52, 0x11111113, s52
    s_mul_i32 s38, s4, 36864
    s_add_u32 s46, s30, s38
    s_addc_u32 s47, s31, 0
    s_cmp_lt_u32 s4, 6
    s_cselect_b32 s92, 7, 6
    s_mul_i32 s93, s4, 7
    s_min_u32 s93, s93, 48
    s_sub_u32 s38, s5, 20
    s_cmp_lt_u32 s38, s92
    s_cselect_b32 s94, 1, 2
    s_cmp_lt_u32 s5, 20
    s_cselect_b32 s94, 0, s94
    s_cmp_ge_u32 s3, 3
    s_cselect_b32 s51, 2, 3
    s_lshl_b32 s38, 2, s94
    s_and_b32 s38, s38, 7
    s_cmp_lt_u32 s3, s38
    s_cselect_b32 s51, s94, s51
    s_cmp_lg_u32 s94, 0
    s_cbranch_scc1 L_PRO_RU
    v_lshrrev_b32 v59, 2, v0
    v_mul_u32_u24 v59, 1280, v59
    v_and_b32 v60, 3, v0
    v_lshl_add_u32 v59, v60, 4, v59
    s_mul_i32 s38, s3, 20480
    s_lshl_b32 s50, s5, 6
    s_add_u32 s38, s38, s50
    s_add_u32 s0, s16, s38
    s_addc_u32 s1, s17, 0
    s_lshr_b32 s39, s3, 1
    s_lshl_b32 s95, s3, 10
    s_lshl_b32 s50, s39, 7
    s_add_u32 s95, s95, s50
    s_add_u32 s95, s95, 20480
    s_branch L_PRO_R
L_PRO_RU:
    v_lshrrev_b32 v59, 2, v0
    v_mul_u32_u24 v59, 3456, v59
    v_and_b32 v60, 3, v0
    v_lshl_add_u32 v59, v60, 4, v59
    s_and_b32 s38, s3, 4
    s_lshl_b32 s38, s38, 2
    v_xor_b32 v59, s38, v59
    s_add_u32 s39, s93, s5
    s_sub_u32 s39, s39, 20
    s_and_b32 s49, s3, 3
    s_cmp_ge_u32 s3, 4
    s_cselect_b32 s0, s22, s20
    s_cselect_b32 s1, s23, s21
    s_mov_b32 s95, 20480
    s_cselect_b32 s95, 64000, s95
    s_lshr_b32 s38, s49, 1
    s_lshl_b32 s50, s49, 10
    s_add_u32 s95, s95, s50
    s_lshl_b32 s50, s38, 7
    s_add_u32 s95, s95, s50
    s_lshl_b32 s38, s39, 6
    s_mul_i32 s50, s49, 55296
    s_add_u32 s38, s38, s50
    s_add_u32 s0, s0, s38
    s_addc_u32 s1, s1, 0
L_PRO_R:
    v_and_b32 v60, 16, v0
    v_lshlrev_b32 v60, 1, v60
    v_xor_b32 v59, v59, v60
    global_load_dwordx4 v[148:151], v58, s[32:33] offset:128 nt
    s_cbranch_vccnz TS_5
    s_waitcnt vmcnt(3)
TS_5:
    v_mov_b32 v48, 0
    v_mov_b32 v49, 0
    v_mov_b32 v50, 0
    v_mov_b32 v51, 0
    v_mov_b32 v52, 0
    v_mov_b32 v53, 0
    v_mov_b32 v54, 0
    v_mov_b32 v55, 0
    v_mov_b32 v32, s54
    v_mov_b32 v33, s54
    v_mov_b32 v34, s54
    v_mov_b32 v35, s54
    v_bfe_u32 v40, v0, 2, 1
    v_mul_u32_u24 v40, 0xaaaa, v40
    v_add_u32 v40, 0x4444, v40
    s_lshl_b32 s38, s3, 11
    v_lshl_add_u32 v11, v0, 4, s38
    v_mov_b32 v12, 0
    s_lshr_b32 s39, s5, 1
    s_and_b32 s49, s5, 1
    s_lshl_b32 s38, s39, 14
    s_lshl_b32 s50, s49, 12
    s_add_u32 s38, s38, s50
    s_lshl_b32 s50, s3, 11
    s_add_u32 s38, s38, s50
    s_lshl_b32 s50, s4, 8
    s_add_u32 s38, s38, s50
    v_lshl_add_u32 v13, v0, 2, s38
    v_mov_b32 v41, 0
    v_mov_b32 v42, 0
    v_mov_b32 v57, 0
    v_mov_b32 v122, 0
    v_mov_b32 v123, 0
    v_and_b32 v17, 7, v0
    v_lshlrev_b32 v17, 5, v17
    v_mov_b32 v18, 0
    v_lshlrev_b32 v19, 4, v0
    v_add_u32 v19, 950272, v19
    s_cmp_lg_u32 s3, 2
    s_cbranch_scc1 L_HA0
    global_load_dword v18, v17, s[28:29] sc1
L_HA0:
    s_add_u32 s98, s98, 16384
    s_and_b32 s98, s98, 0x1ffff
    s_add_u32 s32, s10, s98
    s_addc_u32 s33, s11, 0
    global_load_dwordx4 v[152:155], v58, s[32:33] offset:0 nt
    global_load_dwordx4 v[156:159], v58, s[32:33] offset:128 nt
    s_waitcnt vmcnt(4) lgkmcnt(0)
    s_cmp_lg_u32 s3, 2
    s_cbranch_scc1 L_HA1
    s_lshl_b32 s38, s4, 9
    s_lshl_b32 s50, s5, 4
    s_add_u32 s38, s38, s50
    s_add_u32 s38, s38, 950272
    v_lshl_add_u32 v62, v0, 2, s38
    s_getreg_b32 s48, hwreg(HW_REG_XCC_ID, 0, 4)
    v_mov_b32 v44, s48
    s_mov_b32 s43, 262144
    s_barrier
    s_waitcnt vmcnt(2)
L_ARR:
    v_readlane_b32 s38, v18, s4
    s_nop 0
    s_cmp_lg_u32 s38, 0
    s_cbranch_scc1 L_ARR_OK
    global_load_dword v18, v17, s[28:29] sc1
    s_waitcnt vmcnt(0)
    s_sub_u32 s43, s43, 1
    s_cbranch_scc0 L_ARR
L_ARR_OK:
    s_mov_b64 exec, 1
    global_store_dwordx4 v62, v[44:47], s[30:31] sc1
    s_mov_b64 exec, -1
    s_branch L_PRO_KV
L_HA1:
    s_barrier
    s_cmp_ge_u32 s3, 4
    s_cbranch_scc1 L_PRO_Q
    s_cmp_eq_u32 s3, 3
    s_cbranch_scc1 L_PRO_P
    v_and_b32 v15, 0xffff0000, v14
    v_lshlrev_b32 v14, 16, v14
    s_branch L_PRO_KV
L_PRO_Q:
    s_lshl_b32 s38, s3, 5
    s_add_u32 s38, s38, -128
    v_bfe_u32 v111, v0, 3, 1
    v_lshlrev_b32 v111, 12, v111
    v_lshrrev_b32 v110, 4, v0
    v_lshl_add_u32 v111, v110, 9, v111
    v_bfe_u32 v110, v0, 2, 1
    v_lshl_add_u32 v111, v110, 7, v111
    v_and_b32 v110, 3, v0
    v_lshl_add_u32 v111, v110, 3, v111
    v_add_u32 v111, s38, v111
    ds_read_b64_tr_b16 v[64:65], v111 offset:0
    ds_read_b64_tr_b16 v[66:67], v111 offset:256
    ds_read_b64_tr_b16 v[68:69], v111 offset:2048
    ds_read_b64_tr_b16 v[70:71], v111 offset:2304
    ds_read_b64_tr_b16 v[72:73], v111 offset:8192
    ds_read_b64_tr_b16 v[74:75], v111 offset:8448
    ds_read_b64_tr_b16 v[76:77], v111 offset:10240
    ds_read_b64_tr_b16 v[78:79], v111 offset:10496
    ds_read_b64_tr_b16 v[80:81], v111 offset:16384
    ds_read_b64_tr_b16 v[82:83], v111 offset:16640
    ds_read_b64_tr_b16 v[84:85], v111 offset:18432
    ds_read_b64_tr_b16 v[86:87], v111 offset:18688
    v_mov_b32 v96, 0
    v_mov_b32 v97, 0
    v_mov_b32 v98, 0
    v_mov_b32 v99, 0
    v_mov_b32 v100, 0
    v_mov_b32 v101, 0
    v_mov_b32 v102, 0
    v_mov_b32 v103, 0
    v_mov_b32 v104, 0
    v_mov_b32 v105, 0
    v_mov_b32 v106, 0
    v_mov_b32 v107, 0
    s_mul_i32 s38, s4, 81920
    s_mul_i32 s50, s5, 2560
    s_add_u32 s38, s38, s50
    s_lshl_b32 s50, s3, 8
    s_add_u32 s38, s38, s50
    s_add_u32 s38, s38, 293888
    v_lshl_add_u32 v110, v0, 2, s38
    s_mul_i32 s38, s4, 81920
    s_mul_i32 s50, s5, 2560
    s_add_u32 s38, s38, s50
    s_lshl_b32 s50, s3, 7
    s_add_u32 s38, s38, s50
    s_add_u32 s38, s38, 296448
    v_lshl_add_u32 v112, v0, 2, s38
    v_mov_b32 v116, 0
    v_mov_b32 v117, 0
    v_mov_b32 v118, 0
    v_mov_b32 v119, 0
    v_mov_b32 v120, 0
    v_mov_b32 v121, 0
    v_mov_b32 v122, 0
    v_mov_b32 v123, 0
    v_mov_b32 v124, s54
    v_mov_b32 v125, s54
    v_mov_b32 v126, s54
    v_mov_b32 v127, s54
    s_waitcnt lgkmcnt(0)
    v_smfmac_f32_16x16x64_bf16 v[96:99], v[88:91], v[64:71], v1
    v_smfmac_f32_16x16x64_bf16 v[100:103], v[88:91], v[72:79], v1
    v_smfmac_f32_16x16x64_bf16 v[104:107], v[92:95], v[80:87], v1
    v_smfmac_f32_16x16x64_bf16 v[116:119], v[124:127], v[64:71], v1
    v_smfmac_f32_16x16x64_bf16 v[116:119], v[124:127], v[72:79], v1
    v_smfmac_f32_16x16x64_bf16 v[120:123], v[124:127], v[80:87], v1
    s_nop 2
    v_add_f32 v96, v96, v98
    v_add_f32 v101, v101, v103
    v_add_f32 v96, v96, v101
    v_add_f32 v96, v96, v104
    v_min_u32 v96, -2, v96
    v_add_f32 v116, v116, v118
    v_add_f32 v116, v116, v120
    v_min_u32 v42, -2, v116
    v_mov_b32 v41, v96
    global_store_dword v110, v41, s[30:31]
    s_mov_b32 exec_hi, 0
    global_store_dword v112, v42, s[30:31]
    s_mov_b64 exec, -1
    s_mov_b64 vcc, -1
    s_branch L_PRO_KV
L_PRO_P:
    global_load_dword v18, v17, s[28:29] sc1
    s_and_b32 s39, s5, 24
    s_mul_i32 s38, s4, 81920
    s_mul_i32 s50, s39, 2560
    s_add_u32 s38, s38, s50
    s_lshl_b32 s50, s57, 6
    s_add_u32 s38, s38, s50
    s_add_u32 s38, s38, 298752
    v_lshrrev_b32 v122, 5, v0
    v_mul_u32_u24 v122, 10240, v122
    v_bfe_u32 v125, v0, 3, 2
    v_lshl_add_u32 v122, v125, 8, v122
    v_and_b32 v125, 7, v0
    v_lshl_add_u32 v122, v125, 3, v122
    v_add_u32 v122, s38, v122
    v_lshrrev_b32 v124, 5, v0
    v_lshlrev_b32 v124, 7, v124
    v_bfe_u32 v125, v0, 3, 1
    v_lshl_add_u32 v124, v125, 6, v124
    v_and_b32 v125, 1, v0
    v_lshl_add_u32 v124, v125, 5, v124
    v_bfe_u32 v125, v0, 4, 1
    v_lshl_add_u32 v124, v125, 4, v124
    v_bfe_u32 v125, v0, 1, 2
    v_lshl_add_u32 v124, v125, 2, v124
    v_add_u32 v124, 117248, v124
    s_mul_i32 s38, s4, 81920
    s_mul_i32 s50, s39, 2560
    s_add_u32 s38, s38, s50
    s_add_u32 s38, s38, 300800
    v_lshrrev_b32 v123, 5, v0
    v_mul_u32_u24 v123, 10240, v123
    v_bfe_u32 v125, v0, 3, 2
    v_lshl_add_u32 v123, v125, 7, v123
    v_and_b32 v125, 7, v0
    v_lshl_add_u32 v123, v125, 3, v123
    v_add_u32 v123, s38, v123
    v_dot2_f32_bf16 v120, v24, s54, 0
    v_dot2_f32_bf16 v121, v24, v24, 0
    v_dot2_f32_bf16 v120, v25, s54, v120
    v_dot2_f32_bf16 v121, v25, v25, v121
    v_dot2_f32_bf16 v120, v26, s54, v120
    v_dot2_f32_bf16 v121, v26, v26, v121
    v_dot2_f32_bf16 v120, v27, s54, v120
    v_dot2_f32_bf16 v121, v27, v27, v121
    v_dot2_f32_bf16 v120, v28, s54, v120
    v_dot2_f32_bf16 v121, v28, v28, v121
    s_nop 1
    v_add_f32_dpp v120, v120, v120 quad_perm:[1,0,3,2] row_mask:0xf bank_mask:0xf
    v_add_f32_dpp v121, v121, v121 quad_perm:[1,0,3,2] row_mask:0xf bank_mask:0xf
    s_nop 0
    v_add_f32_dpp v120, v120, v120 quad_perm:[2,3,0,1] row_mask:0xf bank_mask:0xf
    v_add_f32_dpp v121, v121, v121 quad_perm:[2,3,0,1] row_mask:0xf bank_mask:0xf
    s_nop 0
    v_add_f32_dpp v120, v120, v120 row_ror:4 row_mask:0xf bank_mask:0xf
    v_add_f32_dpp v121, v121, v121 row_ror:4 row_mask:0xf bank_mask:0xf
    s_nop 0
    v_add_f32_dpp v120, v120, v120 row_ror:8 row_mask:0xf bank_mask:0xf
    v_add_f32_dpp v121, v121, v121 row_ror:8 row_mask:0xf bank_mask:0xf
    v_mov_b32 v125, v120
    v_mov_b32 v126, v121
    s_nop 0
    v_permlane16_swap_b32 v120, v125
    v_permlane16_swap_b32 v121, v126
    v_add_f32 v120, v120, v125
    v_add_f32 v121, v121, v126
    v_mov_b32 v125, v120
    v_mov_b32 v126, v121
    s_nop 0
    v_permlane32_swap_b32 v120, v125
    v_permlane32_swap_b32 v121, v126
    v_add_f32 v120, v120, v125
    v_add_f32 v121, v121, v126
    v_mul_f32 v120, 0x3acccccd, v120
    v_mul_f32 v121, 0x3acccccd, v121
    v_fma_f32 v121, -v120, v120, v121
    v_max_f32 v121, 0, v121
    v_add_f32 v121, 0x3727c5ac, v121
    v_rsq_f32 v121, v121
L_PRO_KV:
    s_add_u32 s98, s98, 16384
    s_and_b32 s98, s98, 0x1ffff
    s_add_u32 s32, s10, s98
    s_addc_u32 s33, s11, 0
    global_load_dwordx4 v[160:163], v58, s[32:33] offset:0 nt
    s_cbranch_vccnz TS_6
    s_waitcnt vmcnt(3)
TS_6:
    v_lshrrev_b32 v3, 4, v0
    v_lshlrev_b32 v3, 6, v3
    v_and_b32 v61, 3, v0
    v_lshl_add_u32 v3, v61, 4, v3
    v_add_u32 v3, 117248, v3
    s_lshl_b32 s38, s3, 7
    s_add_u32 s38, s38, 117504
    v_and_b32 v4, 1, v0
    v_lshlrev_b32 v4, 6, v4
    v_bfe_u32 v61, v0, 2, 1
    v_lshl_add_u32 v4, v61, 5, v4
    v_bfe_u32 v61, v0, 4, 1
    v_lshl_add_u32 v4, v61, 4, v4
    v_bfe_u32 v61, v0, 1, 1
    v_lshl_add_u32 v4, v61, 3, v4
    v_lshrrev_b32 v61, 5, v0
    v_lshl_add_u32 v4, v61, 2, v4
    v_bfe_u32 v61, v0, 3, 1
    v_lshl_add_u32 v4, v61, 1, v4
    v_add_u32 v4, s38, v4
    v_lshrrev_b32 v5, 4, v0
    v_lshlrev_b32 v5, 5, v5
    v_bfe_u32 v61, v0, 2, 1
    v_lshl_add_u32 v5, v61, 4, v5
    v_add_u32 v5, s38, v5
    s_mul_i32 s38, s3, 1184
    s_add_u32 s38, s38, 107520
    v_and_b32 v6, 15, v0
    v_lshlrev_b32 v6, 4, v6
    v_bfe_u32 v61, v0, 4, 1
    v_lshl_add_u32 v6, v61, 3, v6
    v_lshrrev_b32 v61, 5, v0
    v_mul_u32_u24 v61, 576, v61
    v_add_u32 v6, v6, v61
    v_add_u32 v6, s38, v6
    s_lshl_b32 s38, s3, 3
    s_add_u32 s38, s38, 116992
    v_bfe_u32 v7, v0, 4, 1
    v_lshlrev_b32 v7, 2, v7
    v_add_u32 v7, s38, v7
    s_lshl_b32 s38, s3, 6
    s_add_u32 s38, s38, 107520
    v_and_b32 v8, 3, v0
    v_mul_u32_u24 v8, 2368, v8
    v_bfe_u32 v61, v0, 2, 2
    v_mul_u32_u24 v61, 288, v61
    v_add_u32 v8, v8, v61
    v_lshrrev_b32 v61, 4, v0
    v_lshl_add_u32 v8, v61, 4, v8
    v_add_u32 v8, s38, v8
    v_and_b32 v9, 3, v0
    v_lshlrev_b32 v9, 4, v9
    v_add_u32 v9, 116992, v9
    s_lshr_b32 s39, s3, 1
    s_and_b32 s49, s3, 1
    s_lshl_b32 s38, s39, 10
    s_lshl_b32 s50, s49, 5
    s_add_u32 s38, s38, s50
    s_lshl_b32 s50, s57, 6
    s_add_u32 s38, s38, s50
    s_lshr_b32 s39, s5, 3
    s_and_b32 s49, s5, 1
    s_lshl_b32 s50, s39, 11
    s_add_u32 s38, s38, s50
    s_lshl_b32 s50, s49, 4
    s_add_u32 s38, s38, s50
    v_lshrrev_b32 v10, 4, v0
    v_lshlrev_b32 v10, 8, v10
    v_bfe_u32 v61, v0, 2, 2
    v_lshl_add_u32 v10, v61, 2, v10
    v_add_u32 v10, s38, v10
    s_lshl_b32 s38, s57, 5
    s_lshl_b32 s50, s39, 3
    s_add_u32 s38, s38, s50
    s_lshl_b32 s50, s49, 2
    s_add_u32 s38, s38, s50
    s_add_u32 s38, s38, 15360
    v_writelane_b32 v10, s38, 1
    global_load_dwordx4 v[164:167], v58, s[32:33] offset:128 nt
    s_cbranch_vccnz TS_7
    s_waitcnt vmcnt(3)
TS_7:
    s_add_u32 s98, s98, 16384
    s_and_b32 s98, s98, 0x1ffff
    s_add_u32 s32, s10, s98
    s_addc_u32 s33, s11, 0
    global_load_dwordx4 v[168:171], v58, s[32:33] offset:0 nt
    s_cbranch_vccnz TS_8
    s_waitcnt vmcnt(3)
TS_8:
    global_load_dwordx4 v[172:175], v58, s[32:33] offset:128 nt
    s_cbranch_vccnz TS_9
    s_waitcnt vmcnt(3)
TS_9:
    s_add_u32 s98, s98, 16384
    s_and_b32 s98, s98, 0x1ffff
    s_add_u32 s32, s10, s98
    s_addc_u32 s33, s11, 0
    global_load_dwordx4 v[176:179], v58, s[32:33] offset:0 nt
    s_cbranch_vccnz TS_10
    s_waitcnt vmcnt(3)
TS_10:
    global_load_dwordx4 v[180:183], v58, s[32:33] offset:128 nt
    s_cbranch_vccnz TS_11
    s_waitcnt vmcnt(3)
TS_11:
    s_cmp_eq_u32 s3, 3
    s_cselect_b64 vcc, vcc, 0
    s_add_u32 s98, s98, 16384
    s_and_b32 s98, s98, 0x1ffff
    s_add_u32 s32, s10, s98
    s_addc_u32 s33, s11, 0
    global_load_dwordx4 v[184:187], v58, s[32:33] offset:0 nt
    s_cbranch_vccnz TS_12
    s_waitcnt vmcnt(3)
TS_12:
    s_cmp_lg_u32 s3, 3
    s_cbranch_scc1 L_H1
    s_mov_b32 s43, 262144
    s_waitcnt vmcnt(7)
L_FLG:
    v_cmp_eq_u32 vcc, 0, v18
    s_cbranch_vccz L_FLG_OK
    global_load_dword v18, v17, s[28:29] sc1
    s_waitcnt vmcnt(0)
    s_sub_u32 s43, s43, 1
    s_cbranch_scc0 L_FLG
L_FLG_OK:
    global_load_dword v20, v19, s[30:31] offset:0 sc1
    global_load_dword v21, v19, s[30:31] offset:1024 sc1
    global_load_dword v22, v19, s[30:31] offset:2048 sc1
    global_load_dword v23, v19, s[30:31] offset:3072 sc1
    s_mov_b64 vcc, -1
L_H1:
    global_load_dwordx4 v[188:191], v58, s[32:33] offset:128 nt
    s_cbranch_vccnz TS_13
    s_waitcnt vmcnt(3)
TS_13:
    s_add_u32 s98, s98, 16384
    s_and_b32 s98, s98, 0x1ffff
    s_add_u32 s34, s12, s98
    s_addc_u32 s35, s13, 0
    global_load_dwordx4 v[64:67], v2, s[34:35] offset:0 nt
    s_cbranch_vccnz TS_14
    s_waitcnt vmcnt(3)
TS_14:
    global_load_dwordx4 v[68:71], v2, s[34:35] offset:1024 nt
    s_cbranch_vccnz TS_15
    s_waitcnt vmcnt(3)
TS_15:
    s_cmp_lg_u32 s3, 3
    s_cbranch_scc1 L_H2
    s_getreg_b32 s48, hwreg(HW_REG_XCC_ID, 0, 4)
    s_mov_b32 s43, 262144
    s_waitcnt vmcnt(3)
L_CNT:
    s_bitcmp1_b32 s4, 1
    s_cselect_b64 vcc, -1, 0
    v_cndmask_b32 v17, v20, v21, vcc
    v_cndmask_b32 v18, v22, v23, vcc
    s_bitcmp1_b32 s4, 2
    s_cselect_b64 vcc, -1, 0
    v_cndmask_b32 v17, v17, v18, vcc
    v_cmp_eq_u32 vcc, -1, v17
    s_bitcmp1_b32 s4, 0
    s_cselect_b32 s38, vcc_hi, vcc_lo
    s_cmp_eq_u32 s38, 0
    s_cbranch_scc1 L_CNT_OK
    global_load_dword v20, v19, s[30:31] offset:0 sc1
    global_load_dword v21, v19, s[30:31] offset:1024 sc1
    global_load_dword v22, v19, s[30:31] offset:2048 sc1
    global_load_dword v23, v19, s[30:31] offset:3072 sc1
    s_waitcnt vmcnt(0)
    s_sub_u32 s43, s43, 1
    s_cbranch_scc0 L_CNT
L_CNT_OK:
    global_load_dwordx2 v[112:113], v122, s[30:31] offset:-3840 sc1
    global_load_dwordx2 v[114:115], v122, s[30:31] offset:-1280 sc1
    global_load_dwordx2 v[116:117], v122, s[30:31] offset:1280 sc1
    global_load_dwordx2 v[118:119], v122, s[30:31] offset:3840 sc1
    global_load_dwordx2 v[24:25], v123, s[30:31] offset:-3840 sc1
    global_load_dwordx2 v[26:27], v123, s[30:31] offset:-1280 sc1
    global_load_dwordx2 v[28:29], v123, s[30:31] offset:1280 sc1
    global_load_dwordx2 v[30:31], v123, s[30:31] offset:3840 sc1
    global_load_dword v20, v19, s[30:31] offset:0 sc1
    global_load_dword v21, v19, s[30:31] offset:1024 sc1
    global_load_dword v22, v19, s[30:31] offset:2048 sc1
    global_load_dword v23, v19, s[30:31] offset:3072 sc1
    v_cmp_ne_u32 vcc, s48, v17
    v_mov_b32 v18, 122624
    s_bitcmp1_b32 s4, 0
    s_cselect_b32 s38, vcc_hi, vcc_lo
    s_cmp_lg_u32 s38, 0
    s_cselect_b32 s38, 0, 1
    s_mov_b32 s7, s38
    v_mov_b32 v17, s38
    ds_write_b32 v18, v17
    s_mov_b64 vcc, -1
L_H2:
    s_add_u32 s98, s98, 16384
    s_and_b32 s98, s98, 0x1ffff
    s_add_u32 s34, s12, s98
    s_addc_u32 s35, s13, 0
    global_load_dwordx4 v[72:75], v2, s[34:35] offset:0 nt
    s_cbranch_vccnz TS_16
    s_waitcnt vmcnt(3)
TS_16:
    global_load_dwordx4 v[76:79], v2, s[34:35] offset:1024 nt
    s_cbranch_vccnz TS_17
    s_waitcnt vmcnt(3)
TS_17:
    s_add_u32 s98, s98, 16384
    s_and_b32 s98, s98, 0x1ffff
    s_add_u32 s34, s12, s98
    s_addc_u32 s35, s13, 0
    global_load_dwordx4 v[80:83], v2, s[34:35] offset:0 nt
    s_cbranch_vccnz TS_18
    s_waitcnt vmcnt(3)
TS_18:
    s_cmp_lg_u32 s3, 3
    s_cbranch_scc1 L_H3
    s_waitcnt vmcnt(3)
    s_cmp_eq_u32 s7, 0
    s_cbranch_scc1 L_H3B
    s_mov_b32 s43, 262144
L_Q1:
    v_max3_u32 v125, v24, v25, v26
    v_max3_u32 v125, v125, v27, v28
    v_max3_u32 v125, v125, v29, v30
    v_max3_u32 v125, v125, v31, v112
    v_max3_u32 v125, v125, v113, v114
    v_max3_u32 v125, v125, v115, v116
    v_max3_u32 v125, v125, v117, v118
    v_max_u32 v125, v125, v119
    v_cmp_eq_u32 vcc, -1, v125
    s_cbranch_vccz L_Q1_OK
    global_load_dwordx2 v[112:113], v122, s[30:31] offset:-3840 sc1
    global_load_dwordx2 v[114:115], v122, s[30:31] offset:-1280 sc1
    global_load_dwordx2 v[116:117], v122, s[30:31] offset:1280 sc1
    global_load_dwordx2 v[118:119], v122, s[30:31] offset:3840 sc1
    global_load_dwordx2 v[24:25], v123, s[30:31] offset:-3840 sc1
    global_load_dwordx2 v[26:27], v123, s[30:31] offset:-1280 sc1
    global_load_dwordx2 v[28:29], v123, s[30:31] offset:1280 sc1
    global_load_dwordx2 v[30:31], v123, s[30:31] offset:3840 sc1
    s_waitcnt vmcnt(0)
    s_sub_u32 s43, s43, 1
    s_cbranch_scc0 L_Q1
L_Q1_OK:
    v_pk_add_f32 v[24:25], v[24:25], v[26:27]
    v_pk_add_f32 v[28:29], v[28:29], v[30:31]
    v_pk_add_f32 v[12:13], v[24:25], v[28:29]
    v_mul_f32 v125, v120, v121
    v_mul_f32 v28, -v125, v12
    v_mul_f32 v29, -v125, v13
    v_pk_add_f32 v[24:25], v[112:113], v[114:115]
    v_pk_add_f32 v[26:27], v[116:117], v[118:119]
    v_pk_fma_f32 v[24:25], v[24:25], v[120:121], v[28:29] op_sel:[0,1,0] op_sel_hi:[1,1,1]
    v_pk_fma_f32 v[24:25], v[26:27], v[120:121], v[24:25] op_sel:[0,1,0] op_sel_hi:[1,1,1]
    v_cvt_pk_bf16_f32 v24, v24, v25
    ds_write_b32 v124, v24
L_H3B:
    s_mov_b32 s43, 262144
L_ALL:
    v_max3_u32 v17, v20, v21, v22
    v_max_u32 v17, v17, v23
    v_cmp_eq_u32 vcc, -1, v17
    s_cbranch_vccz L_ALL_OK
    s_sleep 4
    global_load_dword v20, v19, s[30:31] offset:0 sc1
    global_load_dword v21, v19, s[30:31] offset:1024 sc1
    global_load_dword v22, v19, s[30:31] offset:2048 sc1
    global_load_dword v23, v19, s[30:31] offset:3072 sc1
    s_waitcnt vmcnt(0)
    s_sub_u32 s43, s43, 1
    s_cbranch_scc0 L_ALL
L_ALL_OK:
    s_mul_i32 s38, s5, 1152
    v_min_u32 v17, 8, v0
    v_lshl_add_u32 v17, v17, 7, s38
    global_load_dword v56, v17, s[46:47] sc1
    s_mul_i32 s38, s4, 81920
    s_mul_i32 s50, s5, 2560
    s_add_u32 s38, s38, s50
    s_add_u32 s38, s38, 295936
    v_and_b32 v17, 7, v0
    v_lshl_add_u32 v17, v17, 7, s38
    global_load_dword v56, v17, s[30:31] sc1
L_H4:
    s_waitcnt lgkmcnt(0)
    s_mov_b64 vcc, -1
L_H3:
    global_load_dwordx4 v[84:87], v2, s[34:35] offset:1024 nt
    s_cbranch_vccnz TS_19
    s_waitcnt vmcnt(3)
TS_19:
    s_add_u32 s98, s98, 16384
    s_and_b32 s98, s98, 0x1ffff
    s_add_u32 s34, s12, s98
    s_addc_u32 s35, s13, 0
    global_load_dwordx4 v[88:91], v2, s[34:35] offset:0 nt
    s_cbranch_vccnz TS_20
    s_waitcnt vmcnt(3)
TS_20:
    global_load_dwordx4 v[92:95], v2, s[34:35] offset:1024 nt
    s_cbranch_vccnz TS_21
    s_waitcnt vmcnt(3)
TS_21:
    s_add_u32 s98, s98, 16384
    s_and_b32 s98, s98, 0x1ffff
    s_add_u32 s34, s12, s98
    s_addc_u32 s35, s13, 0
    global_load_dwordx4 v[96:99], v2, s[34:35] offset:0 nt
    global_load_dwordx4 v[100:103], v2, s[34:35] offset:1024 nt
    s_waitcnt vmcnt(10)
    v_mov_b32 v62, 122624
    s_barrier
    ds_read_b32 v62, v62
    v_mov_b32 v63, s40
    s_waitcnt lgkmcnt(0)
    v_readfirstlane_b32 s7, v62
    s_nop 0
    s_cmp_eq_u32 s7, 0
    s_cbranch_scc1 L_SLOW
L_SLOW_RET:
    v_mov_b32 v16, 0
    v_mov_b32 v17, 0
    v_mov_b32 v18, 0
    v_mov_b32 v19, 0
    v_mov_b32 v20, 0
    v_mov_b32 v21, 0
    v_mov_b32 v22, 0
    v_mov_b32 v23, 0
    v_mov_b32 v24, 0
    v_mov_b32 v25, 0
    v_mov_b32 v26, 0
    v_mov_b32 v27, 0
    v_mov_b32 v28, 0
    v_mov_b32 v29, 0
    v_mov_b32 v30, 0
    v_mov_b32 v31, 0
    s_mov_b32 exec_lo, 0x000f000f
    s_mov_b32 exec_hi, 0x000f000f
    s_branch L_BAR2
.p2align 12,,2112
PG_22:
L_BAR:
    v_mov_b32 v63, s40
    s_mov_b32 exec_lo, 0x000f000f
    s_mov_b32 exec_hi, 0x000f000f
    s_barrier
L_BAR2:
    ds_read_b128 v[16:19], v3
    s_lshl_b64 exec, exec, 4
    ds_read_b128 v[20:23], v3
    s_lshl_b64 exec, exec, 4
    ds_read_b128 v[24:27], v3
    s_lshl_b64 exec, exec, 4
    ds_read_b128 v[28:31], v3
    s_mov_b64 exec, -1
    s_waitcnt lgkmcnt(3)
    v_smfmac_f32_16x16x64_bf16 v[48:51], v[16:19], v[128:135], v1
    v_smfmac_f32_16x16x64_bf16 v[52:55], v[16:19], v[160:167], v1
    s_waitcnt lgkmcnt(2)
    v_smfmac_f32_16x16x64_bf16 v[48:51], v[20:23], v[136:143], v1
    v_smfmac_f32_16x16x64_bf16 v[52:55], v[20:23], v[168:175], v1
    s_waitcnt lgkmcnt(1)
    v_smfmac_f32_16x16x64_bf16 v[48:51], v[24:27], v[144:151], v1
    v_smfmac_f32_16x16x64_bf16 v[52:55], v[24:27], v[176:183], v1
    s_waitcnt lgkmcnt(0)
    v_smfmac_f32_16x16x64_bf16 v[48:51], v[28:31], v[152:159], v1
    v_smfmac_f32_16x16x64_bf16 v[52:55], v[28:31], v[184:191], v1
    s_nop 6
    v_pk_add_f32 v[48:49], v[48:49], v[50:51]
    v_pk_add_f32 v[52:53], v[52:53], v[54:55]
    v_cndmask_b32 v61, v52, v49, s[58:59]
    v_cndmask_b32 v60, v48, v53, s[58:59]
    s_nop 1
    v_add_f32_dpp v60, v61, v60 quad_perm:[1,0,3,2] row_mask:0xf bank_mask:0xf
    s_nop 1
    v_max_f32_dpp v61, v60, v60 quad_perm:[1,0,3,2] row_mask:0xf bank_mask:0xf
    s_nop 1
    v_max_f32_dpp v61, v61, v61 quad_perm:[2,3,0,1] row_mask:0xf bank_mask:0xf
    s_nop 1
    v_max_f32_dpp v61, v61, v61 row_ror:4 row_mask:0xf bank_mask:0xf
    s_nop 1
    v_max_f32_dpp v61, v61, v61 row_ror:8 row_mask:0xf bank_mask:0xf
    s_nop 1
    v_max_f32_dpp v61, v61, v61 row_bcast:15 row_mask:0xa bank_mask:0xf
    s_nop 1
    v_max_f32_dpp v61, v61, v61 row_bcast:31 row_mask:0xc bank_mask:0xf
    s_nop 0
    v_readlane_b32 s44, v61, 63
    s_nop 1
    v_mul_f32 v61, s44, v63
    v_fma_f32 v60, v60, v63, -v61
    v_exp_f32 v60, v60
    v_min_u32 v61, -2, v61
    v_cvt_pk_bf16_f32 v60, v60, v60
    ds_write_b16 v4, v60
    s_mov_b64 exec, s[96:97]
    ds_read_b128 v[16:19], v5
    s_not_b64 exec, exec
    ds_read_b128 v[28:31], v5
    s_mov_b64 exec, 1
    ds_write_b32 v7, v61 offset:64
    s_mov_b64 exec, -1
    s_cmp_eq_u32 s6, 0
    s_cbranch_scc1 L_VT
L_PV:
    s_waitcnt lgkmcnt(2)
    v_mfma_f32_16x16x32_bf16 v[36:39], v[16:19], v[32:35], 0
    v_smfmac_f32_16x16x64_bf16 v[64:67], v[16:19], v[192:199], v40
    v_smfmac_f32_16x16x64_bf16 v[68:71], v[16:19], v[200:207], v40
    s_waitcnt lgkmcnt(1)
    v_smfmac_f32_16x16x64_bf16 v[64:67], v[28:31], v[224:231], v40
    v_smfmac_f32_16x16x64_bf16 v[68:71], v[28:31], v[232:239], v40
    v_smfmac_f32_16x16x64_bf16 v[72:75], v[16:19], v[208:215], v40
    v_smfmac_f32_16x16x64_bf16 v[76:79], v[16:19], v[216:223], v40
    ds_read_b128 v[20:23], v9 offset:64
    v_smfmac_f32_16x16x64_bf16 v[72:75], v[28:31], v[240:247], v40
    v_smfmac_f32_16x16x64_bf16 v[76:79], v[28:31], v[248:255], v40
    s_cmp_eq_u32 s6, 0
    s_nop 1
    ds_write2_b32 v6, v64, v68 offset0:0 offset1:1
    s_mov_b64 exec, 0x10001
    ds_write_b32 v7, v36
    s_mov_b64 exec, -1
    s_nop 0
    ds_write2_b32 v6, v72, v76 offset0:72 offset1:73
    s_cbranch_scc1 L_E1
    s_cmp_ge_u32 s3, 4
    s_cbranch_scc1 L_YB
    s_waitcnt lgkmcnt(3)
    s_mov_b32 s43, 262144
L_MXC:
    v_max_u32 v60, v20, v22
    v_cmp_eq_u32 vcc, -1, v60
    v_max_f32 v61, v20, v22
    s_cbranch_vccnz L_MXR
L_MXD:
    s_nop 0
    v_max_f32_dpp v61, v61, v61 quad_perm:[1,0,3,2] row_mask:0xf bank_mask:0xf
    s_nop 1
    v_max_f32_dpp v61, v61, v61 quad_perm:[2,3,0,1] row_mask:0xf bank_mask:0xf
    v_sub_f32 v44, v20, v61
    v_sub_f32 v45, v22, v61
    v_exp_f32 v44, v44
    v_exp_f32 v45, v45
    s_cmp_ge_u32 s3, 4
L_YB:
    s_waitcnt lgkmcnt(0)
    s_barrier
    s_cbranch_scc1 L_ATT_END
    ds_read_b128 v[20:23], v9
    ds_read_b128 v[24:27], v8
    ds_read_b128 v[28:31], v8 offset:1184
    s_cmp_eq_u32 s7, 0
    s_waitcnt lgkmcnt(2)
    v_add_f32 v20, v20, v21
    v_add_f32 v22, v22, v23
    v_mul_f32 v60, v44, v20
    v_fmac_f32 v60, v45, v22
    s_waitcnt lgkmcnt(0)
    v_pk_add_f32 v[24:25], v[24:25], v[26:27]
    v_add_f32_dpp v60, v60, v60 quad_perm:[1,0,3,2] row_mask:0xf bank_mask:0xf
    v_pk_add_f32 v[28:29], v[28:29], v[30:31]
    v_pk_mul_f32 v[24:25], v[24:25], v[44:45] op_sel_hi:[1,0]
    v_add_f32_dpp v60, v60, v60 quad_perm:[2,3,0,1] row_mask:0xf bank_mask:0xf
    v_pk_fma_f32 v[24:25], v[28:29], v[44:45], v[24:25] op_sel:[0,1,0] op_sel_hi:[1,1,1]
    v_rcp_f32 v46, v60
    v_log_f32 v60, v60
    v_add_f32_dpp v24, v24, v24 quad_perm:[1,0,3,2] row_mask:0xf bank_mask:0xf
    v_add_f32_dpp v25, v25, v25 quad_perm:[1,0,3,2] row_mask:0xf bank_mask:0xf
    v_add_f32 v20, v60, v61
    v_add_f32_dpp v24, v24, v24 quad_perm:[2,3,0,1] row_mask:0xf bank_mask:0xf
    v_add_f32_dpp v25, v25, v25 quad_perm:[2,3,0,1] row_mask:0xf bank_mask:0xf
    s_mov_b32 exec_lo, s53
    v_pk_mul_f32 v[24:25], v[24:25], v[46:47] op_sel_hi:[1,0]
    v_cvt_pk_bf16_f32 v20, v24, v25
    s_mov_b64 exec, s[52:53]
    v_min_u32 v24, -2, v20
    s_cbranch_scc1 SG_23
    global_store_dword v10, v24, s[46:47]
    s_branch SE_24
SG_23:
    global_store_dword v10, v24, s[46:47] sc1
SE_24:
    s_mov_b64 exec, -1
L_ATT_END:
    s_cmp_eq_u32 s6, 0
    s_cbranch_scc1 L_STAGE
L_ROLE:
    s_cmp_lg_u32 s55, 0
    s_cbranch_scc1 L_ROLE2
    s_mul_i32 s38, s3, 8704
    s_add_u32 s38, s38, 20480
    v_bfe_u32 v6, v0, 3, 1
    v_mul_u32_u24 v6, 2176, v6
    v_lshrrev_b32 v7, 4, v0
    v_lshl_add_u32 v6, v7, 8, v6
    v_bfe_u32 v7, v0, 2, 1
    v_lshl_add_u32 v6, v7, 6, v6
    v_and_b32 v7, 3, v0
    v_lshl_add_u32 v6, v7, 3, v6
    v_add_u32 v6, s38, v6
    v_and_b32 v7, 16, v0
    v_lshl_add_u32 v5, v7, 1, v6
    v_xor_b32 v7, 16, v7
    v_lshl_add_u32 v6, v7, 1, v6
    ds_read_b64_tr_b16 v[64:65], v5 offset:0
    ds_read_b64_tr_b16 v[66:67], v5 offset:128
    ds_read_b64_tr_b16 v[68:69], v5 offset:1024
    ds_read_b64_tr_b16 v[70:71], v5 offset:1152
    ds_read_b64_tr_b16 v[72:73], v5 offset:4352
    ds_read_b64_tr_b16 v[74:75], v5 offset:4480
    ds_read_b64_tr_b16 v[76:77], v5 offset:5376
    ds_read_b64_tr_b16 v[78:79], v5 offset:5504
    ds_read_b64_tr_b16 v[80:81], v6 offset:0
    ds_read_b64_tr_b16 v[82:83], v6 offset:128
    ds_read_b64_tr_b16 v[84:85], v6 offset:1024
    ds_read_b64_tr_b16 v[86:87], v6 offset:1152
    ds_read_b64_tr_b16 v[88:89], v6 offset:4352
    ds_read_b64_tr_b16 v[90:91], v6 offset:4480
    ds_read_b64_tr_b16 v[92:93], v6 offset:5376
    ds_read_b64_tr_b16 v[94:95], v6 offset:5504
    s_lshl_b32 s38, s3, 3
    s_add_u32 s38, s38, 15360
    v_lshrrev_b32 v3, 4, v0
    v_lshlrev_b32 v3, 5, v3
    v_add_u32 v3, s38, v3
    s_waitcnt vmcnt(0)
    global_load_dwordx4 v[16:19], v11, s[46:47] offset:0 sc1
    global_load_dwordx4 v[20:23], v11, s[46:47] offset:1024 sc1
    global_load_dwordx2 v[24:25], v3, s[46:47] sc1
    s_mov_b32 s43, 262144
    v_mov_b32 v48, 0
    v_mov_b32 v49, 0
    v_mov_b32 v50, 0
    v_mov_b32 v51, 0
    v_mov_b32 v52, 0
    v_mov_b32 v53, 0
    v_mov_b32 v54, 0
    v_mov_b32 v55, 0
    s_lshl_b32 s38, s6, 11
    s_lshl_b32 s50, s3, 8
    s_add_u32 s38, s38, s50
    s_add_u32 s38, s38, 118528
    v_lshl_add_u32 v4, v0, 2, s38
    s_lshl_b32 s38, s6, 11
    s_lshl_b32 s50, s3, 10
    s_add_u32 s38, s38, s50
    s_add_u32 s38, s38, 118528
    v_lshl_add_u32 v10, v0, 2, s38
    s_lshr_b32 s39, s56, 2
    s_and_b32 s49, s56, 3
    s_lshl_b32 s38, s39, 14
    s_lshl_b32 s50, s49, 11
    s_add_u32 s38, s38, s50
    v_lshl_add_u32 v2, v0, 4, s38
    s_mul_i32 s38, s6, 327680
    s_add_u32 s38, s38, 966656
    s_add_u32 s34, s30, s38
    s_addc_u32 s35, s31, 0
    s_add_u32 s32, s34, 8192
    s_addc_u32 s33, s35, 0
    s_waitcnt lgkmcnt(0)
    s_branch PC_26
PM_25:
    s_mov_b64 exec, s[8:9]
    global_load_dwordx4 v[16:19], v11, s[46:47] offset:0 sc1
    s_mov_b64 exec, s[10:11]
    global_load_dwordx4 v[20:23], v11, s[46:47] offset:1024 sc1
    s_mov_b64 exec, s[12:13]
    global_load_dwordx2 v[24:25], v3, s[46:47] sc1
    s_mov_b64 exec, -1
    s_sub_u32 s43, s43, 1
    s_cbranch_scc1 PD_27
PC_26:
    s_waitcnt vmcnt(2)
    v_max3_u32 v7, v16, v17, v18
    v_max_u32 v7, v7, v19
    v_cmp_eq_u32 s[8:9], -1, v7
    s_waitcnt vmcnt(1)
    v_max3_u32 v7, v20, v21, v22
    v_max_u32 v7, v7, v23
    v_cmp_eq_u32 s[10:11], -1, v7
    s_waitcnt vmcnt(0)
    v_max_u32 v7, v24, v25
    v_cmp_eq_u32 s[12:13], -1, v7
    s_or_b64 s[44:45], s[8:9], s[10:11]
    s_or_b64 s[44:45], s[44:45], s[12:13]
    s_cbranch_scc1 PM_25
PD_27:
    v_smfmac_f32_16x16x64_bf16 v[48:51], v[16:19], v[64:71], v1
    v_sub_f32 v8, v25, v24
    v_smfmac_f32_16x16x64_bf16 v[48:51], v[20:23], v[72:79], v1
    v_exp_f32 v8, v8
    v_smfmac_f32_16x16x64_bf16 v[52:55], v[16:19], v[80:87], v1
    v_add_f32 v8, 1.0, v8
    v_smfmac_f32_16x16x64_bf16 v[52:55], v[20:23], v[88:95], v1
    v_rcp_f32 v8, v8
    s_mov_b32 s43, 262144
    s_cmp_ge_u32 s3, 2
    v_sub_f32 v9, 1.0, v8
    v_pk_add_f32 v[48:49], v[48:49], v[50:51]
    v_mul_f32 v48, v8, v48
    v_fmac_f32 v48, v9, v49
    s_nop 0
    v_pk_add_f32 v[52:53], v[52:53], v[54:55]
    v_min_u32 v48, -2, v48
    v_mul_f32 v52, v8, v52
    v_fmac_f32 v52, v9, v53
    v_min_u32 v52, -2, v52
    ds_write2st64_b32 v4, v48, v52 offset0:0 offset1:4
    s_cbranch_scc1 L_ROLE2
L_OXP:
    ds_read2st64_b32 v[56:57], v10 offset0:0 offset1:1
    ds_read2st64_b32 v[58:59], v10 offset0:2 offset1:3
    s_sub_u32 s43, s43, 1
    s_cbranch_scc1 L_OXD
    s_waitcnt lgkmcnt(0)
    v_max3_u32 v7, v56, v57, v58
    v_max_u32 v7, v7, v59
    v_cmp_eq_u32 vcc, -1, v7
    v_pk_add_f32 v[60:61], v[56:57], v[58:59]
    s_cbranch_vccnz L_OXP
L_OXD:
    v_add_f32 v60, v60, v61
    v_min_u32 v60, -2, v60
    global_store_dword v13, v60, s[34:35] sc1
    global_store_dword v13, v60, s[32:33] sc1
    s_waitcnt vmcnt(2)
    s_lshr_b32 s39, s56, 3
    s_and_b32 s49, s56, 7
    s_lshl_b32 s39, s39, 10
    s_mov_b32 s38, s39
    s_add_u32 s38, s38, 8192
    s_and_b32 s39, s49, 1
    s_lshl_b32 s39, s39, 9
    s_and_b32 s50, s49, 2
    s_lshl_b32 s50, s50, 4
    s_add_u32 s39, s39, s50
    s_and_b32 s50, s49, 4
    s_lshl_b32 s50, s50, 2
    s_add_u32 s39, s39, s50
    s_lshl_b32 s50, s49, 7
    s_cmp_ge_u32 s49, 8
    s_cselect_b32 s39, s50, s39
    s_cselect_b32 s49, 4, 6
    s_add_u32 s38, s38, s39
    v_bfe_u32 v4, v0, 1, 1
    v_lshlrev_b32 v4, 2, v4
    v_bfe_u32 v5, v0, 2, 2
    v_lshl_add_u32 v4, v5, 0, v4
    v_lshlrev_b32 v4, s49, v4
    v_and_b32 v5, 1, v0
    v_lshl_add_u32 v4, v5, 3, v4
    v_lshrrev_b32 v5, 5, v0
    v_lshl_add_u32 v4, v5, 2, v4
    v_add_u32 v4, s38, v4
    s_cmp_lg_u32 s6, 0
    s_cbranch_scc1 NR_28
    s_waitcnt vmcnt(1)
    s_nop 3
    s_getreg_b32 s38, hwreg(HW_REG_IB_STS, 0, 4)
    s_cmp_eq_u32 s38, 0
    s_cselect_b32 s48, 8192, 0
    s_waitcnt vmcnt(0)
    s_branch NR_29
NR_28:
    s_sleep 7
NR_29:
    s_add_u32 s36, s34, s48
    s_addc_u32 s37, s35, 0
    global_load_dwordx4 v[16:19], v2, s[36:37] offset:0 sc1
    global_load_dwordx4 v[20:23], v2, s[36:37] offset:1024 sc1
    s_mov_b32 s43, 262144
    s_branch PC_31
PM_30:
    s_mov_b64 exec, s[8:9]
    global_load_dwordx4 v[16:19], v2, s[36:37] offset:0 sc1
    s_mov_b64 exec, s[10:11]
    global_load_dwordx4 v[20:23], v2, s[36:37] offset:1024 sc1
    s_mov_b64 exec, -1
    s_sub_u32 s43, s43, 1
    s_cbranch_scc1 PD_32
PC_31:
    s_waitcnt vmcnt(1)
    v_max3_u32 v5, v16, v17, v18
    v_max_u32 v5, v5, v19
    v_cmp_eq_u32 s[8:9], -1, v5
    s_waitcnt vmcnt(0)
    v_max3_u32 v5, v20, v21, v22
    v_max_u32 v5, v5, v23
    v_cmp_eq_u32 s[10:11], -1, v5
    s_nop 0
    s_or_b64 s[44:45], s[8:9], s[10:11]
    s_cbranch_scc1 PM_30
PD_32:
    v_pk_add_f32 v[48:49], v[16:17], v[20:21]
    v_pk_add_f32 v[50:51], v[18:19], v[22:23]
    s_nop 1
    v_permlane32_swap_b32 v48, v50
    v_permlane32_swap_b32 v49, v51
    v_pk_add_f32 v[48:49], v[48:49], v[50:51]
    v_mov_b32 v50, v48
    v_mov_b32 v51, v49
    s_nop 0
    v_permlane16_swap_b32 v48, v50
    v_permlane16_swap_b32 v49, v51
    v_pk_add_f32 v[48:49], v[48:49], v[50:51]
    v_cvt_pk_bf16_f32 v48, v48, v49
    v_and_b32 v49, 0xffff0000, v48
    v_lshlrev_b32 v48, 16, v48
    v_pk_add_f32 v[48:49], v[48:49], v[14:15]
    v_cvt_pk_bf16_f32 v48, v48, v49
    s_mov_b32 exec_lo, 0xffff
    s_mov_b32 exec_hi, 0xffff
    s_cmp_eq_u32 s7, 0
    v_min_u32 v49, -2, v48
    s_cbranch_scc1 SG_33
    global_store_dword v4, v49, s[46:47]
    s_branch SE_34
SG_33:
    global_store_dword v4, v49, s[46:47] sc1
SE_34:
    s_mov_b64 exec, -1
    v_and_b32 v15, 0xffff0000, v48
    v_lshlrev_b32 v14, 16, v48
    s_lshl_b32 s38, s3, 2
    s_add_u32 s38, s38, 122640
    v_mov_b32 v3, s38
    ds_write_b32 v3, v0
    s_branch L_DN
.p2align 12,,3168
PG_46:
L_MXR:
    ds_read_b128 v[20:23], v9 offset:64
    s_waitcnt lgkmcnt(0)
    s_sub_u32 s43, s43, 1
    s_cbranch_scc0 L_MXC
    s_branch L_MXD
L_MXRV:
    ds_read_b128 v[20:23], v9 offset:64
    s_waitcnt lgkmcnt(0)
    s_sub_u32 s43, s43, 1
    s_cbranch_scc0 L_MXCV
    s_branch L_MXDV
L_E1:
    s_cmp_lg_u32 s94, 0
    s_cbranch_scc1 L_E2
    s_waitcnt vmcnt(0)
L_E2:
    s_cmp_ge_u32 s3, 4
    s_branch L_YB
L_VT:
    s_add_u32 s98, s98, 16384
    s_and_b32 s98, s98, 0x1ffff
    s_add_u32 s34, s12, s98
    s_addc_u32 s35, s13, 0
    global_load_dwordx4 v[104:107], v2, s[34:35] offset:0 nt
    s_waitcnt vmcnt(3)
TS_47:
    s_waitcnt vmcnt(9)
    v_perm_b32 v192, v68, v64, s41
    v_perm_b32 v200, v68, v64, s42
    v_perm_b32 v208, v69, v65, s41
    v_perm_b32 v216, v69, v65, s42
    v_perm_b32 v224, v70, v66, s41
    v_perm_b32 v232, v70, v66, s42
    v_perm_b32 v240, v71, v67, s41
    v_perm_b32 v248, v71, v67, s42
    global_load_dwordx4 v[108:111], v2, s[34:35] offset:1024 nt
    s_waitcnt vmcnt(3)
TS_48:
    s_waitcnt vmcnt(8)
    v_perm_b32 v193, v76, v72, s41
    v_perm_b32 v201, v76, v72, s42
    v_perm_b32 v209, v77, v73, s41
    v_perm_b32 v217, v77, v73, s42
    v_perm_b32 v225, v78, v74, s41
    v_perm_b32 v233, v78, v74, s42
    v_perm_b32 v241, v79, v75, s41
    v_perm_b32 v249, v79, v75, s42
    s_add_u32 s98, s98, 16384
    s_and_b32 s98, s98, 0x1ffff
    s_add_u32 s34, s12, s98
    s_addc_u32 s35, s13, 0
    global_load_dwordx4 v[112:115], v2, s[34:35] offset:0 nt
    s_waitcnt vmcnt(3)
TS_49:
    s_waitcnt vmcnt(7)
    v_perm_b32 v194, v84, v80, s41
    v_perm_b32 v202, v84, v80, s42
    v_perm_b32 v210, v85, v81, s41
    v_perm_b32 v218, v85, v81, s42
    v_perm_b32 v226, v86, v82, s41
    v_perm_b32 v234, v86, v82, s42
    v_perm_b32 v242, v87, v83, s41
    v_perm_b32 v250, v87, v83, s42
    global_load_dwordx4 v[116:119], v2, s[34:35] offset:1024 nt
    s_waitcnt vmcnt(3)
TS_50:
    s_waitcnt vmcnt(6)
    v_perm_b32 v195, v92, v88, s41
    v_perm_b32 v203, v92, v88, s42
    v_perm_b32 v211, v93, v89, s41
    v_perm_b32 v219, v93, v89, s42
    v_perm_b32 v227, v94, v90, s41
    v_perm_b32 v235, v94, v90, s42
    v_perm_b32 v243, v95, v91, s41
    v_perm_b32 v251, v95, v91, s42
    s_add_u32 s98, s98, 16384
    s_and_b32 s98, s98, 0x1ffff
    s_add_u32 s34, s12, s98
    s_addc_u32 s35, s13, 0
    global_load_dwordx4 v[120:123], v2, s[34:35] offset:0 nt
    s_waitcnt vmcnt(3)
TS_51:
    s_sub_u32 s38, s5, 20
    s_cmp_lt_u32 s38, 7
    s_cbranch_scc1 L_WPE
    s_cmp_ge_u32 s5, 20
    s_cselect_b32 s38, 7, 0
    s_sub_u32 s38, s5, s38
    s_mul_i32 s38, s38, 208
    s_mul_i32 s50, s3, 26
    s_add_u32 s38, s38, s50
    v_min_u32 v57, 25, v0
    v_add_u32 v57, s38, v57
    v_min_u32 v57, 5119, v57
    v_mul_u32_u24 v58, 3277, v57
    v_lshrrev_b32 v58, 22, v58
    v_add_u32 v62, s4, v58
    v_and_b32 v62, 7, v62
    v_mul_u32_u24 v58, 7, v58
    v_add_u32 v62, v62, v58
    v_mul_u32_u24 v62, 1280, v62
    v_add_lshl_u32 v57, v57, v62, 7
    global_load_dword v56, v57, s[16:17]
L_WPE:
    global_load_dwordx4 v[124:127], v2, s[34:35] offset:1024 nt
    s_lshr_b32 s55, s3, 2
    s_or_b32 s55, s55, s94
    v_mov_b32 v64, 0
    v_mov_b32 v65, 0
    v_mov_b32 v66, 0
    v_mov_b32 v67, 0
    v_mov_b32 v68, 0
    v_mov_b32 v69, 0
    v_mov_b32 v70, 0
    v_mov_b32 v71, 0
    v_mov_b32 v72, 0
    v_mov_b32 v73, 0
    v_mov_b32 v74, 0
    v_mov_b32 v75, 0
    v_mov_b32 v76, 0
    v_mov_b32 v77, 0
    v_mov_b32 v78, 0
    v_mov_b32 v79, 0
    ds_read_b128 v[20:23], v9 offset:64
    s_waitcnt lgkmcnt(0)
    s_mov_b32 s43, 262144
L_MXCV:
    v_max_u32 v60, v20, v22
    v_cmp_eq_u32 vcc, -1, v60
    v_max_f32 v61, v20, v22
    s_cbranch_vccnz L_MXRV
L_MXDV:
    s_nop 0
    v_max_f32_dpp v61, v61, v61 quad_perm:[1,0,3,2] row_mask:0xf bank_mask:0xf
    s_nop 1
    v_max_f32_dpp v61, v61, v61 quad_perm:[2,3,0,1] row_mask:0xf bank_mask:0xf
    v_sub_f32 v44, v20, v61
    v_sub_f32 v45, v22, v61
    v_exp_f32 v44, v44
    v_exp_f32 v45, v45
    s_waitcnt vmcnt(6)
    v_perm_b32 v196, v100, v96, s41
    v_perm_b32 v204, v100, v96, s42
    v_perm_b32 v212, v101, v97, s41
    v_perm_b32 v220, v101, v97, s42
    v_perm_b32 v228, v102, v98, s41
    v_perm_b32 v236, v102, v98, s42
    v_perm_b32 v244, v103, v99, s41
    v_perm_b32 v252, v103, v99, s42
    s_waitcnt vmcnt(4)
    v_perm_b32 v197, v108, v104, s41
    v_perm_b32 v205, v108, v104, s42
    v_perm_b32 v213, v109, v105, s41
    v_perm_b32 v221, v109, v105, s42
    v_perm_b32 v229, v110, v106, s41
    v_perm_b32 v237, v110, v106, s42
    v_perm_b32 v245, v111, v107, s41
    v_perm_b32 v253, v111, v107, s42
    s_add_u32 s38, s4, 0
    s_and_b32 s38, s38, 7
    s_add_u32 s38, s38, 0
    s_mul_i32 s8, s38, 163840
    s_add_u32 s38, s4, 1
    s_and_b32 s38, s38, 7
    s_add_u32 s38, s38, 8
    s_mul_i32 s9, s38, 163840
    s_add_u32 s38, s4, 2
    s_and_b32 s38, s38, 7
    s_add_u32 s38, s38, 16
    s_mul_i32 s10, s38, 163840
    s_add_u32 s38, s4, 3
    s_and_b32 s38, s38, 7
    s_add_u32 s38, s38, 24
    s_mul_i32 s11, s38, 163840
    s_waitcnt vmcnt(2)
    v_perm_b32 v198, v116, v112, s41
    v_perm_b32 v206, v116, v112, s42
    v_perm_b32 v214, v117, v113, s41
    v_perm_b32 v222, v117, v113, s42
    v_perm_b32 v230, v118, v114, s41
    v_perm_b32 v238, v118, v114, s42
    v_perm_b32 v246, v119, v115, s41
    v_perm_b32 v254, v119, v115, s42
    s_cmp_eq_u32 s94, 0
    s_cbranch_scc1 L_NT0
    s_lshl_b32 s39, s5, 3
    s_add_u32 s39, s39, s3
    s_add_u32 s39, s39, -160
    s_cmp_ge_u32 s39, 48
    s_cselect_b32 s36, s22, s20
    s_cselect_b32 s37, s23, s21
    s_cselect_b32 s38, 48, 0
    s_sub_u32 s39, s39, s38
    s_mul_i32 s39, s39, 14
    s_add_u32 s39, s39, 0
    s_lshr_b32 s49, s93, 1
    s_lshl_b32 s49, s49, 7
    s_sub_u32 s38, s92, 4
    v_lshrrev_b32 v57, 2, v0
    v_min_u32 v57, 6, v57
    v_add_u32 v57, s39, v57
    v_min_u32 v57, 639, v57
    v_mul_u32_u24 v57, 3456, v57
    v_and_b32 v58, 3, v0
    v_min_u32 v58, s38, v58
    v_lshl_add_u32 v57, v58, 7, v57
    v_add_u32 v57, s49, v57
L_NT0:
    s_waitcnt vmcnt(0)
    v_perm_b32 v199, v124, v120, s41
    v_perm_b32 v207, v124, v120, s42
    v_perm_b32 v215, v125, v121, s41
    v_perm_b32 v223, v125, v121, s42
    v_perm_b32 v231, v126, v122, s41
    v_perm_b32 v239, v126, v122, s42
    v_perm_b32 v247, v127, v123, s41
    v_perm_b32 v255, v127, v123, s42
    s_cmp_eq_u32 s94, 0
    s_cbranch_scc1 L_NT1
    global_load_dword v56, v57, s[36:37]
    s_branch L_PV
L_NT1:
    s_add_u32 m0, s95, 0
    s_add_u32 s36, s0, s8
    s_addc_u32 s37, s1, 0
    global_load_lds_dwordx4 v59, s[36:37]
    s_add_u32 m0, s95, 8704
    s_add_u32 s36, s0, s9
    s_addc_u32 s37, s1, 0
    global_load_lds_dwordx4 v59, s[36:37]
    s_add_u32 m0, s95, 17408
    s_add_u32 s36, s0, s10
    s_addc_u32 s37, s1, 0
    global_load_lds_dwordx4 v59, s[36:37]
    s_add_u32 m0, s95, 26112
    s_add_u32 s36, s0, s11
    s_addc_u32 s37, s1, 0
    global_load_lds_dwordx4 v59, s[36:37]
    s_nop 1
    s_branch L_PV
L_STAGE:
    s_cmp_lg_u32 s94, 0
    s_cbranch_scc1 L_RG_U
    s_mul_i32 s38, s93, 40960
    s_add_u32 s0, s24, s38
    s_addc_u32 s1, s25, 0
    v_mov_b32 v41, v59
    s_branch L_ROLE
L_RG_U:
    s_barrier
    s_lshl_b32 s39, s5, 3
    s_add_u32 s39, s39, s3
    s_add_u32 s39, s39, -160
    s_cmp_ge_u32 s39, 48
    s_cselect_b32 s36, s22, s20
    s_cselect_b32 s37, s23, s21
    s_cselect_b32 s38, 48, 0
    s_sub_u32 s39, s39, s38
    s_mul_i32 s39, s39, 14
    s_add_u32 s39, s39, 7
    s_lshr_b32 s49, s93, 1
    s_lshl_b32 s49, s49, 7
    s_sub_u32 s38, s92, 4
    v_lshrrev_b32 v57, 2, v0
    v_min_u32 v57, 6, v57
    v_add_u32 v57, s39, v57
    v_min_u32 v57, 639, v57
    v_mul_u32_u24 v57, 3456, v57
    v_and_b32 v58, 3, v0
    v_min_u32 v58, s38, v58
    v_lshl_add_u32 v57, v58, 7, v57
    v_add_u32 v57, s49, v57
    global_load_dword v56, v57, s[36:37]
    s_cmp_lt_u32 s5, 27
    s_cbranch_scc1 L_RG_G
    s_lshl_b32 s39, s5, 3
    s_add_u32 s39, s39, s3
    s_add_u32 s39, s39, -216
    s_mul_i32 s38, s93, 40960
    s_add_u32 s36, s24, s38
    s_addc_u32 s37, s25, 0
    s_mul_i32 s38, s39, s92
    s_lshl_b32 s38, s38, 3
    s_lshl_b32 s39, s92, 3
    s_sub_u32 s39, s39, 1
    v_min_u32 v57, s39, v0
    v_add_u32 v57, s38, v57
    v_lshlrev_b32 v57, 7, v57
    s_barrier
    global_load_dword v56, v57, s[36:37]
L_RG_G:
    s_waitcnt vmcnt(0)
    s_cmp_lg_u32 s94, 1
    s_cbranch_scc1 L_ROLE2
    s_add_u32 m0, s95, 0
    s_nop 0
    global_load_lds_dwordx4 v59, s[0:1]
    s_add_u32 s0, s0, 221184
    s_addc_u32 s1, s1, 0
    s_add_u32 m0, s95, 4352
    s_nop 0
    global_load_lds_dwordx4 v59, s[0:1]
    s_add_u32 s0, s0, 221184
    s_addc_u32 s1, s1, 0
    s_add_u32 m0, s95, 8704
    s_nop 0
    global_load_lds_dwordx4 v59, s[0:1]
    s_add_u32 s0, s0, 221184
    s_addc_u32 s1, s1, 0
    s_add_u32 m0, s95, 13056
    s_nop 0
    global_load_lds_dwordx4 v59, s[0:1]
    s_add_u32 s0, s0, 221184
    s_addc_u32 s1, s1, 0
    s_add_u32 m0, s95, 17408
    s_nop 0
    global_load_lds_dwordx4 v59, s[0:1]
    s_add_u32 s0, s0, 221184
    s_addc_u32 s1, s1, 0
    s_add_u32 m0, s95, 21760
    s_nop 0
    global_load_lds_dwordx4 v59, s[0:1]
    s_add_u32 s0, s0, 221184
    s_addc_u32 s1, s1, 0
    s_add_u32 m0, s95, 26112
    s_nop 0
    global_load_lds_dwordx4 v59, s[0:1]
    s_add_u32 s0, s0, 221184
    s_addc_u32 s1, s1, 0
    s_add_u32 m0, s95, 30464
    s_nop 0
    global_load_lds_dwordx4 v59, s[0:1]
    s_add_u32 s0, s0, 221184
    s_addc_u32 s1, s1, 0
    s_add_u32 m0, s95, 34816
    s_nop 0
    global_load_lds_dwordx4 v59, s[0:1]
    s_add_u32 s0, s0, 221184
    s_addc_u32 s1, s1, 0
    s_add_u32 m0, s95, 39168
    s_nop 0
    global_load_lds_dwordx4 v59, s[0:1]
    s_waitcnt vmcnt(0)
    s_barrier
L_ROLE2:
    s_waitcnt vmcnt(0)
    s_cmp_eq_u32 s51, 2
    s_cbranch_scc1 L_HI
    s_cmp_eq_u32 s51, 3
    s_cbranch_scc1 L_W2
    s_mov_b32 s38, 10240
    v_lshl_add_u32 v3, v0, 4, s38
    global_load_dwordx4 v[28:31], v3, s[46:47] offset:-2048 sc1
    global_load_dwordx4 v[32:35], v3, s[46:47] offset:-1024 sc1
    global_load_dwordx4 v[36:39], v3, s[46:47] offset:0 sc1
    global_load_dwordx4 v[40:43], v3, s[46:47] offset:1024 sc1
    global_load_dwordx4 v[44:47], v3, s[46:47] offset:2048 sc1
    s_mov_b32 s43, 262144
    v_bfe_u32 v4, v0, 4, 1
    v_lshlrev_b32 v4, 5, v4
    v_bfe_u32 v5, v0, 1, 1
    v_lshl_add_u32 v4, v5, 4, v4
    s_lshl_b32 s38, s3, 4
    v_xor_b32 v4, s38, v4
    v_bfe_u32 v6, v0, 3, 1
    v_mul_u32_u24 v6, 2176, v6
    v_lshrrev_b32 v5, 4, v0
    v_lshl_add_u32 v6, v5, 8, v6
    v_bfe_u32 v5, v0, 2, 1
    v_lshl_add_u32 v6, v5, 6, v6
    v_and_b32 v5, 1, v0
    v_lshl_add_u32 v6, v5, 3, v6
    v_bfe_u32 v5, v0, 1, 1
    v_mul_u32_u24 v5, 43520, v5
    v_add_u32 v6, v6, v5
    v_add_u32 v6, 20480, v6
    v_add_u32 v6, v6, v4
    v_mov_b32 v8, s54
    v_mov_b32 v9, s54
    v_mov_b32 v10, s54
    v_mov_b32 v11, s54
    v_mov_b32 v16, 0
    v_mov_b32 v17, 0
    v_mov_b32 v18, 0
    v_mov_b32 v19, 0
    ds_read_b64_tr_b16 v[48:49], v6 offset:0
    ds_read_b64_tr_b16 v[50:51], v6 offset:128
    ds_read_b64_tr_b16 v[52:53], v6 offset:1024
    ds_read_b64_tr_b16 v[54:55], v6 offset:1152
    ds_read_b64_tr_b16 v[56:57], v6 offset:4352
    ds_read_b64_tr_b16 v[58:59], v6 offset:4480
    ds_read_b64_tr_b16 v[60:61], v6 offset:5376
    ds_read_b64_tr_b16 v[62:63], v6 offset:5504
    ds_read_b64_tr_b16 v[64:65], v6 offset:8704
    ds_read_b64_tr_b16 v[66:67], v6 offset:8832
    ds_read_b64_tr_b16 v[68:69], v6 offset:9728
    ds_read_b64_tr_b16 v[70:71], v6 offset:9856
    ds_read_b64_tr_b16 v[72:73], v6 offset:13056
    ds_read_b64_tr_b16 v[74:75], v6 offset:13184
    ds_read_b64_tr_b16 v[76:77], v6 offset:14080
    ds_read_b64_tr_b16 v[78:79], v6 offset:14208
    s_waitcnt lgkmcnt(12)
    v_smfmac_f32_16x16x64_bf16 v[16:19], v[8:11], v[48:55], v1
    ds_read_b64_tr_b16 v[80:81], v6 offset:17408
    ds_read_b64_tr_b16 v[82:83], v6 offset:17536
    ds_read_b64_tr_b16 v[84:85], v6 offset:18432
    ds_read_b64_tr_b16 v[86:87], v6 offset:18560
    s_waitcnt lgkmcnt(12)
    v_smfmac_f32_16x16x64_bf16 v[16:19], v[8:11], v[56:63], v1
    ds_read_b64_tr_b16 v[88:89], v6 offset:21760
    ds_read_b64_tr_b16 v[90:91], v6 offset:21888
    ds_read_b64_tr_b16 v[92:93], v6 offset:22784
    ds_read_b64_tr_b16 v[94:95], v6 offset:22912
    s_waitcnt lgkmcnt(12)
    v_smfmac_f32_16x16x64_bf16 v[16:19], v[8:11], v[64:71], v1
    ds_read_b64_tr_b16 v[96:97], v6 offset:26112
    ds_read_b64_tr_b16 v[98:99], v6 offset:26240
    ds_read_b64_tr_b16 v[100:101], v6 offset:27136
    ds_read_b64_tr_b16 v[102:103], v6 offset:27264
    s_waitcnt lgkmcnt(12)
    v_smfmac_f32_16x16x64_bf16 v[16:19], v[8:11], v[72:79], v1
    ds_read_b64_tr_b16 v[104:105], v6 offset:30464
    ds_read_b64_tr_b16 v[106:107], v6 offset:30592
    ds_read_b64_tr_b16 v[108:109], v6 offset:31488
    ds_read_b64_tr_b16 v[110:111], v6 offset:31616
    s_waitcnt lgkmcnt(12)
    v_smfmac_f32_16x16x64_bf16 v[16:19], v[8:11], v[80:87], v1
    ds_read_b64_tr_b16 v[112:113], v6 offset:34816
    ds_read_b64_tr_b16 v[114:115], v6 offset:34944
    ds_read_b64_tr_b16 v[116:117], v6 offset:35840
    ds_read_b64_tr_b16 v[118:119], v6 offset:35968
    s_waitcnt lgkmcnt(12)
    v_smfmac_f32_16x16x64_bf16 v[16:19], v[8:11], v[88:95], v1
    ds_read_b64_tr_b16 v[120:121], v6 offset:39168
    ds_read_b64_tr_b16 v[122:123], v6 offset:39296
    ds_read_b64_tr_b16 v[124:125], v6 offset:40192
    ds_read_b64_tr_b16 v[126:127], v6 offset:40320
    s_waitcnt lgkmcnt(12)
    v_smfmac_f32_16x16x64_bf16 v[16:19], v[8:11], v[96:103], v1
    s_sub_u32 s39, s5, 20
    s_lshr_b32 s38, s39, 2
    s_lshl_b32 s38, s38, 10
    s_and_b32 s49, s39, 2
    s_and_b32 s39, s39, 1
    s_lshl_b32 s50, s49, 3
    s_add_u32 s38, s38, s50
    s_lshl_b32 s50, s39, 5
    s_add_u32 s38, s38, s50
    s_lshl_b32 s50, s3, 8
    s_add_u32 s38, s38, s50
    s_add_u32 s38, s38, 13312
    v_lshrrev_b32 v4, 4, v0
    v_lshlrev_b32 v4, 6, v4
    v_bfe_u32 v6, v0, 1, 2
    v_lshl_add_u32 v4, v6, 2, v4
    v_add_u32 v4, s38, v4
    v_mov_b32 v20, 0
    v_mov_b32 v21, 0
    v_mov_b32 v22, 0
    v_mov_b32 v23, 0
    v_mov_b32 v24, 0
    v_mov_b32 v25, 0
    v_mov_b32 v26, 0
    v_mov_b32 v27, 0
    s_waitcnt lgkmcnt(8)
    v_smfmac_f32_16x16x64_bf16 v[16:19], v[8:11], v[104:111], v1
    s_waitcnt lgkmcnt(4)
    v_smfmac_f32_16x16x64_bf16 v[16:19], v[8:11], v[112:119], v1
    s_waitcnt lgkmcnt(0)
    v_smfmac_f32_16x16x64_bf16 v[16:19], v[8:11], v[120:127], v1
    s_nop 7
    v_add_f32 v5, v16, v18
    v_mul_f32 v5, 0x3acccccd, v5
    s_branch PC_53
PM_52:
    s_mov_b64 exec, s[8:9]
    global_load_dwordx4 v[28:31], v3, s[46:47] offset:-2048 sc1
    s_mov_b64 exec, s[10:11]
    global_load_dwordx4 v[32:35], v3, s[46:47] offset:-1024 sc1
    s_mov_b64 exec, s[12:13]
    global_load_dwordx4 v[36:39], v3, s[46:47] offset:0 sc1
    s_mov_b64 exec, s[14:15]
    global_load_dwordx4 v[40:43], v3, s[46:47] offset:1024 sc1
    s_mov_b64 exec, s[16:17]
    global_load_dwordx4 v[44:47], v3, s[46:47] offset:2048 sc1
    s_mov_b64 exec, -1
    s_sub_u32 s43, s43, 1
    s_cbranch_scc1 PD_54
PC_53:
    s_waitcnt vmcnt(4)
    v_mfma_f32_16x16x32_bf16 v[16:19], v[28:31], v[8:11], 0
    v_max3_u32 v6, v28, v29, v30
    v_max_u32 v6, v6, v31
    v_cmp_eq_u32 s[8:9], -1, v6
    s_waitcnt vmcnt(3)
    v_mfma_f32_16x16x32_bf16 v[16:19], v[32:35], v[8:11], v[16:19]
    v_max3_u32 v6, v32, v33, v34
    v_max_u32 v6, v6, v35
    v_cmp_eq_u32 s[10:11], -1, v6
    s_waitcnt vmcnt(2)
    v_mfma_f32_16x16x32_bf16 v[16:19], v[36:39], v[8:11], v[16:19]
    v_max3_u32 v6, v36, v37, v38
    v_max_u32 v6, v6, v39
    v_cmp_eq_u32 s[12:13], -1, v6
    s_or_b64 s[44:45], s[8:9], s[10:11]
    s_waitcnt vmcnt(1)
    v_mfma_f32_16x16x32_bf16 v[16:19], v[40:43], v[8:11], v[16:19]
    v_max3_u32 v6, v40, v41, v42
    v_max_u32 v6, v6, v43
    v_cmp_eq_u32 s[14:15], -1, v6
    s_or_b64 s[44:45], s[44:45], s[12:13]
    s_waitcnt vmcnt(0)
    v_mfma_f32_16x16x32_bf16 v[16:19], v[44:47], v[8:11], v[16:19]
    v_max3_u32 v6, v44, v45, v46
    v_max_u32 v6, v6, v47
    v_cmp_eq_u32 s[16:17], -1, v6
    s_or_b64 s[44:45], s[44:45], s[14:15]
    s_or_b64 s[44:45], s[44:45], s[16:17]
    s_cbranch_scc1 PM_52
PD_54:
    v_smfmac_f32_16x16x64_bf16 v[20:23], v[28:31], v[48:55], v1
    v_smfmac_f32_16x16x64_bf16 v[24:27], v[28:31], v[56:63], v1
    v_smfmac_f32_16x16x64_bf16 v[20:23], v[32:35], v[64:71], v1
    v_smfmac_f32_16x16x64_bf16 v[24:27], v[32:35], v[72:79], v1
    v_smfmac_f32_16x16x64_bf16 v[20:23], v[36:39], v[80:87], v1
    v_smfmac_f32_16x16x64_bf16 v[24:27], v[36:39], v[88:95], v1
    v_smfmac_f32_16x16x64_bf16 v[20:23], v[40:43], v[96:103], v1
    v_smfmac_f32_16x16x64_bf16 v[24:27], v[40:43], v[104:111], v1
    v_pk_add_f32 v[16:17], v[16:17], v[18:19]
    v_smfmac_f32_16x16x64_bf16 v[20:23], v[44:47], v[112:119], v1
    v_add_f32 v16, v16, v17
    v_smfmac_f32_16x16x64_bf16 v[24:27], v[44:47], v[120:127], v1
    s_mov_b32 s44, 0x00550055
    s_mov_b32 s45, 0x00550055
    s_cmp_eq_u32 s7, 0
    s_nop 2
    v_add_f32 v20, v20, v22
    s_nop 0
    v_add_f32 v25, v25, v27
    v_fma_f32 v20, -v16, v5, v20
    v_add_f32 v20, v20, v25
    v_cvt_pk_bf16_f32 v20, v20, v20
    v_and_b32 v20, 0xffff0000, v20
    v_max_f32 v21, 0, v20
    s_nop 1
    v_mul_f32_dpp v21, v20, v21 row_ror:8 row_mask:0xf bank_mask:0xf
    s_nop 1
    v_mov_b32_dpp v20, v21 quad_perm:[1,1,3,3] row_mask:0xf bank_mask:0xf
    v_cvt_pk_bf16_f32 v20, v21, v20
    v_min_u32 v20, -2, v20
    s_mov_b64 exec, s[44:45]
    s_cbranch_scc1 SG_55
    global_store_dword v4, v20, s[46:47]
    s_branch SE_56
SG_55:
    global_store_dword v4, v20, s[46:47] sc1
SE_56:
    s_mov_b64 exec, -1
L_IDLE:
    s_cmp_lg_u32 s6, 0
    s_cbranch_scc1 L_FIN
L_NEXT:
    s_waitcnt vmcnt(0)
    s_cmp_eq_u32 s3, 3
    s_cbranch_scc1 L_HI
    v_lshrrev_b32 v3, 4, v0
    v_lshlrev_b32 v3, 6, v3
    v_and_b32 v61, 3, v0
    v_lshl_add_u32 v3, v61, 4, v3
    v_add_u32 v3, 117248, v3
    s_lshl_b32 s38, s3, 7
    s_add_u32 s38, s38, 117504
    v_and_b32 v4, 1, v0
    v_lshlrev_b32 v4, 6, v4
    v_bfe_u32 v61, v0, 2, 1
    v_lshl_add_u32 v4, v61, 5, v4
    v_bfe_u32 v61, v0, 4, 1
    v_lshl_add_u32 v4, v61, 4, v4
    v_bfe_u32 v61, v0, 1, 1
    v_lshl_add_u32 v4, v61, 3, v4
    v_lshrrev_b32 v61, 5, v0
    v_lshl_add_u32 v4, v61, 2, v4
    v_bfe_u32 v61, v0, 3, 1
    v_lshl_add_u32 v4, v61, 1, v4
    v_add_u32 v4, s38, v4
    v_lshrrev_b32 v5, 4, v0
    v_lshlrev_b32 v5, 5, v5
    v_bfe_u32 v61, v0, 2, 1
    v_lshl_add_u32 v5, v61, 4, v5
    v_add_u32 v5, s38, v5
    s_mul_i32 s38, s3, 1184
    s_add_u32 s38, s38, 107520
    v_and_b32 v6, 15, v0
    v_lshlrev_b32 v6, 4, v6
    v_bfe_u32 v61, v0, 4, 1
    v_lshl_add_u32 v6, v61, 3, v6
    v_lshrrev_b32 v61, 5, v0
    v_mul_u32_u24 v61, 576, v61
    v_add_u32 v6, v6, v61
    v_add_u32 v6, s38, v6
    s_lshl_b32 s38, s3, 3
    s_add_u32 s38, s38, 117120
    v_bfe_u32 v7, v0, 4, 1
    v_lshlrev_b32 v7, 2, v7
    v_add_u32 v7, s38, v7
    s_lshl_b32 s38, s3, 6
    s_add_u32 s38, s38, 107520
    v_and_b32 v8, 3, v0
    v_mul_u32_u24 v8, 2368, v8
    v_bfe_u32 v61, v0, 2, 2
    v_mul_u32_u24 v61, 288, v61
    v_add_u32 v8, v8, v61
    v_lshrrev_b32 v61, 4, v0
    v_lshl_add_u32 v8, v61, 4, v8
    v_add_u32 v8, s38, v8
    v_and_b32 v9, 3, v0
    v_lshlrev_b32 v9, 4, v9
    v_add_u32 v9, 117120, v9
    s_lshr_b32 s39, s3, 1
    s_and_b32 s49, s3, 1
    s_lshl_b32 s38, s39, 10
    s_lshl_b32 s50, s49, 5
    s_add_u32 s38, s38, s50
    s_lshl_b32 s50, s57, 6
    s_add_u32 s38, s38, s50
    s_lshr_b32 s39, s5, 3
    s_and_b32 s49, s5, 1
    s_lshl_b32 s50, s39, 11
    s_add_u32 s38, s38, s50
    s_lshl_b32 s50, s49, 4
    s_add_u32 s38, s38, s50
    v_lshrrev_b32 v10, 4, v0
    v_lshlrev_b32 v10, 8, v10
    v_bfe_u32 v61, v0, 2, 2
    v_lshl_add_u32 v10, v61, 2, v10
    v_add_u32 v10, s38, v10
    s_lshl_b32 s38, s57, 5
    s_lshl_b32 s50, s39, 3
    s_add_u32 s38, s38, s50
    s_lshl_b32 s50, s49, 2
    s_add_u32 s38, s38, s50
    s_add_u32 s38, s38, 15360
    v_writelane_b32 v10, s38, 1
    v_mov_b32 v16, 0
    v_mov_b32 v17, 0
    v_mov_b32 v18, 0
    v_mov_b32 v19, 0
    v_mov_b32 v20, 0
    v_mov_b32 v21, 0
    v_mov_b32 v22, 0
    v_mov_b32 v23, 0
    v_mov_b32 v24, 0
    v_mov_b32 v25, 0
    v_mov_b32 v26, 0
    v_mov_b32 v27, 0
    v_mov_b32 v28, 0
    v_mov_b32 v29, 0
    v_mov_b32 v30, 0
    v_mov_b32 v31, 0
    v_mov_b32 v48, 0
    v_mov_b32 v49, 0
    v_mov_b32 v50, 0
    v_mov_b32 v51, 0
    v_mov_b32 v52, 0
    v_mov_b32 v53, 0
    v_mov_b32 v54, 0
    v_mov_b32 v55, 0
    v_mov_b32 v64, 0
    v_mov_b32 v65, 0
    v_mov_b32 v66, 0
    v_mov_b32 v67, 0
    v_mov_b32 v68, 0
    v_mov_b32 v69, 0
    v_mov_b32 v70, 0
    v_mov_b32 v71, 0
    v_mov_b32 v72, 0
    v_mov_b32 v73, 0
    v_mov_b32 v74, 0
    v_mov_b32 v75, 0
    v_mov_b32 v76, 0
    v_mov_b32 v77, 0
    v_mov_b32 v78, 0
    v_mov_b32 v79, 0
    v_mov_b32 v32, s54
    v_mov_b32 v33, s54
    v_mov_b32 v34, s54
    v_mov_b32 v35, s54
    v_bfe_u32 v40, v0, 2, 1
    v_mul_u32_u24 v40, 0xaaaa, v40
    v_add_u32 v40, 0x4444, v40
    s_waitcnt lgkmcnt(0)
    s_mov_b32 s6, 1
    s_add_u32 s46, s46, 15488
    s_addc_u32 s47, s47, 0
    s_branch L_BAR
.p2align 12,,1280
PG_35:
L_DN:
    s_mov_b32 s38, 13312
    v_lshl_add_u32 v3, v0, 4, s38
    s_cmp_eq_u32 s92, 6
    s_cselect_b32 s39, 2, 0
    v_or_b32 v6, s39, v0
    v_lshrrev_b32 v7, 1, v6
    v_and_b32 v6, v6, v7
    v_and_b32 v6, 1, v6
    v_lshlrev_b32 v6, 4, v6
    v_sub_u32 v4, v3, v6
    v_add_u32 v5, 163840, v13
    v_add_u32 v2, 163840, v2
    v_bfe_u32 v7, v0, 4, 1
    v_lshlrev_b32 v7, 5, v7
    s_lshl_b32 s38, s3, 5
    v_xor_b32 v9, s38, v7
    v_bfe_u32 v6, v0, 3, 1
    v_mul_u32_u24 v6, 2176, v6
    v_lshrrev_b32 v7, 4, v0
    v_lshl_add_u32 v6, v7, 8, v6
    v_bfe_u32 v7, v0, 2, 1
    v_lshl_add_u32 v6, v7, 6, v6
    v_and_b32 v7, 3, v0
    v_lshl_add_u32 v6, v7, 3, v6
    v_add_u32 v6, 55296, v6
    v_add_u32 v6, v6, v9
    v_mov_b32 v56, 0
    v_mov_b32 v57, 0
    v_mov_b32 v58, 0
    v_mov_b32 v59, 0
    v_mov_b32 v60, 0
    v_mov_b32 v61, 0
    v_mov_b32 v62, 0
    v_mov_b32 v63, 0
    global_load_dwordx4 v[48:51], v3, s[46:47] sc1
    global_load_dwordx4 v[52:55], v4, s[46:47] offset:1024 sc1
    s_mov_b32 s43, 262144
    v_mov_b32 v10, 122648
L_DNF:
    ds_read_b32 v9, v10
    s_sub_u32 s43, s43, 1
    s_cbranch_scc1 L_DNG
    s_waitcnt lgkmcnt(0)
    v_cmp_eq_u32 vcc, -1, v9
    s_cbranch_vccnz L_DNF
L_DNG:
    ds_read_b64_tr_b16 v[64:65], v6 offset:0
    ds_read_b64_tr_b16 v[66:67], v6 offset:128
    ds_read_b64_tr_b16 v[68:69], v6 offset:1024
    ds_read_b64_tr_b16 v[70:71], v6 offset:1152
    ds_read_b64_tr_b16 v[72:73], v6 offset:4352
    ds_read_b64_tr_b16 v[74:75], v6 offset:4480
    ds_read_b64_tr_b16 v[76:77], v6 offset:5376
    ds_read_b64_tr_b16 v[78:79], v6 offset:5504
    ds_read_b64_tr_b16 v[80:81], v6 offset:8704
    ds_read_b64_tr_b16 v[82:83], v6 offset:8832
    ds_read_b64_tr_b16 v[84:85], v6 offset:9728
    ds_read_b64_tr_b16 v[86:87], v6 offset:9856
    ds_read_b64_tr_b16 v[88:89], v6 offset:13056
    ds_read_b64_tr_b16 v[90:91], v6 offset:13184
    ds_read_b64_tr_b16 v[92:93], v6 offset:14080
    ds_read_b64_tr_b16 v[94:95], v6 offset:14208
    s_mov_b32 s43, 262144
L_DNH:
    ds_read_b32 v9, v10 offset:4
    s_sub_u32 s43, s43, 1
    s_cbranch_scc1 L_DNI
    s_waitcnt lgkmcnt(0)
    v_cmp_eq_u32 vcc, -1, v9
    s_cbranch_vccnz L_DNH
L_DNI:
    v_readfirstlane_b32 s48, v9
    s_nop 0
    s_and_b32 s48, s48, 8192
    s_mov_b32 s43, 262144
    global_load_dwordx4 v[48:51], v3, s[46:47] sc1
    global_load_dwordx4 v[52:55], v4, s[46:47] offset:1024 sc1
    s_nop 11
    s_branch PC_37
PM_36:
    s_mov_b64 exec, s[8:9]
    global_load_dwordx4 v[48:51], v3, s[46:47] sc1
    s_mov_b64 exec, s[10:11]
    global_load_dwordx4 v[52:55], v4, s[46:47] offset:1024 sc1
    s_mov_b64 exec, -1
    s_sub_u32 s43, s43, 1
    s_cbranch_scc1 PD_38
PC_37:
    s_waitcnt vmcnt(3)
    v_max3_u32 v7, v48, v49, v50
    v_max_u32 v7, v7, v51
    v_cmp_eq_u32 s[8:9], -1, v7
    s_waitcnt vmcnt(2)
    v_max3_u32 v7, v52, v53, v54
    v_max_u32 v7, v7, v55
    v_cmp_eq_u32 s[10:11], -1, v7
    s_nop 0
    s_or_b64 s[44:45], s[8:9], s[10:11]
    s_cbranch_scc1 PM_36
PD_38:
    v_smfmac_f32_16x16x64_bf16 v[56:59], v[48:51], v[64:71], v1
    v_smfmac_f32_16x16x64_bf16 v[60:63], v[48:51], v[72:79], v1
    v_smfmac_f32_16x16x64_bf16 v[56:59], v[52:55], v[80:87], v1
    v_smfmac_f32_16x16x64_bf16 v[60:63], v[52:55], v[88:95], v1
    s_and_b32 s38, s56, 7
    s_cmp_lg_u32 s38, s4
    s_cselect_b32 s38, s6, 0
    s_cmp_lg_u32 s38, 0
    s_nop 2
    v_add_f32 v56, v56, v58
    v_add_f32 v61, v61, v63
    v_add_f32 v56, v56, v61
    v_min_u32 v56, -2, v56
    global_store_dword v5, v56, s[34:35] sc1
    global_store_dword v5, v56, s[32:33] sc1
    s_cbranch_scc1 L_FIN
    s_waitcnt vmcnt(2)
    s_mul_i32 s39, s56, 26
    s_lshr_b32 s39, s39, 8
    s_mul_i32 s49, s39, 10
    s_sub_u32 s49, s56, s49
    s_mul_i32 s39, s39, 1280
    s_mov_b32 s38, s39
    s_add_u32 s38, s38, 30976
    s_and_b32 s39, s49, 1
    s_lshl_b32 s39, s39, 9
    s_and_b32 s50, s49, 2
    s_lshl_b32 s50, s50, 4
    s_add_u32 s39, s39, s50
    s_and_b32 s50, s49, 4
    s_lshl_b32 s50, s50, 2
    s_add_u32 s39, s39, s50
    s_lshl_b32 s50, s49, 7
    s_cmp_ge_u32 s49, 8
    s_cselect_b32 s39, s50, s39
    s_cselect_b32 s49, 4, 6
    s_add_u32 s38, s38, s39
    v_bfe_u32 v4, v0, 1, 1
    v_lshlrev_b32 v4, 2, v4
    v_bfe_u32 v5, v0, 2, 2
    v_lshl_add_u32 v4, v5, 0, v4
    v_lshlrev_b32 v4, s49, v4
    v_and_b32 v5, 1, v0
    v_lshl_add_u32 v4, v5, 3, v4
    v_lshrrev_b32 v5, 5, v0
    v_lshl_add_u32 v4, v5, 2, v4
    v_add_u32 v4, s38, v4
    s_lshl_b32 s38, s56, 5
    v_bfe_u32 v6, v0, 2, 2
    v_mul_u32_u24 v6, 1280, v6
    v_and_b32 v7, 3, v0
    v_lshl_add_u32 v6, v7, 3, v6
    v_lshrrev_b32 v7, 5, v0
    v_lshl_add_u32 v6, v7, 2, v6
    v_add_u32 v6, s38, v6
    s_add_u32 s36, s34, s48
    s_addc_u32 s37, s35, 0
    s_sleep 7
    global_load_dwordx4 v[16:19], v2, s[36:37] offset:0 sc1
    global_load_dwordx4 v[20:23], v2, s[36:37] offset:1024 sc1
    s_mov_b32 s43, 262144
    s_lshl_b32 s38, s6, 6
    s_add_u32 s38, s38, 122688
    v_and_b32 v9, 15, v0
    v_lshlrev_b32 v9, 2, v9
    v_add_u32 v9, s38, v9
    s_mov_b32 s43, 262144
L_XS:
    ds_read_b32 v8, v9
    s_sub_u32 s43, s43, 1
    s_cbranch_scc1 L_XS_OK
    s_waitcnt lgkmcnt(0)
    v_cmp_eq_u32 vcc, -1, v8
    s_cbranch_vccnz L_XS
L_XS_OK:
    s_mov_b32 s43, 262144
    s_branch PC_42
PM_41:
    s_mov_b64 exec, s[8:9]
    global_load_dwordx4 v[16:19], v2, s[36:37] offset:0 sc1
    s_mov_b64 exec, s[10:11]
    global_load_dwordx4 v[20:23], v2, s[36:37] offset:1024 sc1
    s_mov_b64 exec, -1
    s_sub_u32 s43, s43, 1
    s_cbranch_scc1 PD_43
PC_42:
    s_waitcnt vmcnt(1)
    v_max3_u32 v5, v16, v17, v18
    v_max_u32 v5, v5, v19
    v_cmp_eq_u32 s[8:9], -1, v5
    s_waitcnt vmcnt(0)
    v_max3_u32 v5, v20, v21, v22
    v_max_u32 v5, v5, v23
    v_cmp_eq_u32 s[10:11], -1, v5
    s_nop 0
    s_or_b64 s[44:45], s[8:9], s[10:11]
    s_cbranch_scc1 PM_41
PD_43:
    v_pk_add_f32 v[48:49], v[16:17], v[20:21]
    v_pk_add_f32 v[50:51], v[18:19], v[22:23]
    s_nop 1
    v_permlane32_swap_b32 v48, v50
    v_permlane32_swap_b32 v49, v51
    v_pk_add_f32 v[48:49], v[48:49], v[50:51]
    v_mov_b32 v50, v48
    v_mov_b32 v51, v49
    s_nop 0
    v_permlane16_swap_b32 v48, v50
    v_permlane16_swap_b32 v49, v51
    v_pk_add_f32 v[48:49], v[48:49], v[50:51]
    v_pk_mul_f32 v[48:49], v[48:49], v[8:9] op_sel_hi:[1,0]
    v_cvt_pk_bf16_f32 v48, v48, v49
    v_and_b32 v49, 0xffff0000, v48
    v_lshlrev_b32 v48, 16, v48
    v_pk_add_f32 v[48:49], v[48:49], v[14:15]
    v_cvt_pk_bf16_f32 v48, v48, v49
    s_mov_b32 exec_lo, 0xffff
    s_mov_b32 exec_hi, 0xffff
    s_cmp_eq_u32 s6, 0
    s_cbranch_scc1 L_RED2P
    global_store_dword v6, v48, s[26:27]
    s_endpgm
L_RED2P:
    s_cmp_eq_u32 s7, 0
    v_min_u32 v49, -2, v48
    s_cbranch_scc1 SG_44
    global_store_dword v4, v49, s[46:47]
    s_branch SE_45
SG_44:
    global_store_dword v4, v49, s[46:47] sc1
SE_45:
    s_mov_b64 exec, -1
    v_and_b32 v15, 0xffff0000, v48
    v_lshlrev_b32 v14, 16, v48
    s_branch L_NEXT
L_HI:
    s_cmp_lg_u32 s6, 0
    s_cbranch_scc1 L_FIN
    s_waitcnt vmcnt(0)
    v_lshrrev_b32 v3, 4, v0
    v_lshlrev_b32 v3, 6, v3
    v_and_b32 v61, 3, v0
    v_lshl_add_u32 v3, v61, 4, v3
    v_add_u32 v3, 117248, v3
    s_lshl_b32 s38, s3, 7
    s_add_u32 s38, s38, 117504
    v_and_b32 v4, 1, v0
    v_lshlrev_b32 v4, 6, v4
    v_bfe_u32 v61, v0, 2, 1
    v_lshl_add_u32 v4, v61, 5, v4
    v_bfe_u32 v61, v0, 4, 1
    v_lshl_add_u32 v4, v61, 4, v4
    v_bfe_u32 v61, v0, 1, 1
    v_lshl_add_u32 v4, v61, 3, v4
    v_lshrrev_b32 v61, 5, v0
    v_lshl_add_u32 v4, v61, 2, v4
    v_bfe_u32 v61, v0, 3, 1
    v_lshl_add_u32 v4, v61, 1, v4
    v_add_u32 v4, s38, v4
    v_lshrrev_b32 v5, 4, v0
    v_lshlrev_b32 v5, 5, v5
    v_bfe_u32 v61, v0, 2, 1
    v_lshl_add_u32 v5, v61, 4, v5
    v_add_u32 v5, s38, v5
    s_mul_i32 s38, s3, 1184
    s_add_u32 s38, s38, 107520
    v_and_b32 v6, 15, v0
    v_lshlrev_b32 v6, 4, v6
    v_bfe_u32 v61, v0, 4, 1
    v_lshl_add_u32 v6, v61, 3, v6
    v_lshrrev_b32 v61, 5, v0
    v_mul_u32_u24 v61, 576, v61
    v_add_u32 v6, v6, v61
    v_add_u32 v6, s38, v6
    s_lshl_b32 s38, s3, 3
    s_add_u32 s38, s38, 117120
    v_bfe_u32 v7, v0, 4, 1
    v_lshlrev_b32 v7, 2, v7
    v_add_u32 v7, s38, v7
    s_lshl_b32 s38, s3, 6
    s_add_u32 s38, s38, 107520
    v_and_b32 v8, 3, v0
    v_mul_u32_u24 v8, 2368, v8
    v_bfe_u32 v61, v0, 2, 2
    v_mul_u32_u24 v61, 288, v61
    v_add_u32 v8, v8, v61
    v_lshrrev_b32 v61, 4, v0
    v_lshl_add_u32 v8, v61, 4, v8
    v_add_u32 v8, s38, v8
    v_and_b32 v9, 3, v0
    v_lshlrev_b32 v9, 4, v9
    v_add_u32 v9, 117120, v9
    s_lshr_b32 s39, s3, 1
    s_and_b32 s49, s3, 1
    s_lshl_b32 s38, s39, 10
    s_lshl_b32 s50, s49, 5
    s_add_u32 s38, s38, s50
    s_lshl_b32 s50, s57, 6
    s_add_u32 s38, s38, s50
    s_lshr_b32 s39, s5, 3
    s_and_b32 s49, s5, 1
    s_lshl_b32 s50, s39, 11
    s_add_u32 s38, s38, s50
    s_lshl_b32 s50, s49, 4
    s_add_u32 s38, s38, s50
    v_lshrrev_b32 v10, 4, v0
    v_lshlrev_b32 v10, 8, v10
    v_bfe_u32 v61, v0, 2, 2
    v_lshl_add_u32 v10, v61, 2, v10
    v_add_u32 v10, s38, v10
    s_lshl_b32 s38, s57, 5
    s_lshl_b32 s50, s39, 3
    s_add_u32 s38, s38, s50
    s_lshl_b32 s50, s49, 2
    s_add_u32 s38, s38, s50
    s_add_u32 s38, s38, 15360
    v_writelane_b32 v10, s38, 1
    v_mov_b32 v16, 0
    v_mov_b32 v17, 0
    v_mov_b32 v18, 0
    v_mov_b32 v19, 0
    v_mov_b32 v20, 0
    v_mov_b32 v21, 0
    v_mov_b32 v22, 0
    v_mov_b32 v23, 0
    v_mov_b32 v24, 0
    v_mov_b32 v25, 0
    v_mov_b32 v26, 0
    v_mov_b32 v27, 0
    v_mov_b32 v28, 0
    v_mov_b32 v29, 0
    v_mov_b32 v30, 0
    v_mov_b32 v31, 0
    v_mov_b32 v48, 0
    v_mov_b32 v49, 0
    v_mov_b32 v50, 0
    v_mov_b32 v51, 0
    v_mov_b32 v52, 0
    v_mov_b32 v53, 0
    v_mov_b32 v54, 0
    v_mov_b32 v55, 0
    v_mov_b32 v64, 0
    v_mov_b32 v65, 0
    v_mov_b32 v66, 0
    v_mov_b32 v67, 0
    v_mov_b32 v68, 0
    v_mov_b32 v69, 0
    v_mov_b32 v70, 0
    v_mov_b32 v71, 0
    v_mov_b32 v72, 0
    v_mov_b32 v73, 0
    v_mov_b32 v74, 0
    v_mov_b32 v75, 0
    v_mov_b32 v76, 0
    v_mov_b32 v77, 0
    v_mov_b32 v78, 0
    v_mov_b32 v79, 0
    v_mov_b32 v32, s54
    v_mov_b32 v33, s54
    v_mov_b32 v34, s54
    v_mov_b32 v35, s54
    v_bfe_u32 v40, v0, 2, 1
    v_mul_u32_u24 v40, 0xaaaa, v40
    v_add_u32 v40, 0x4444, v40
    s_add_u32 s46, s46, 15488
    s_addc_u32 s47, s47, 0
    s_cmp_eq_u32 s3, 3
    s_cbranch_scc1 L_POLLER
    s_lshl_b32 s38, s3, 5
    s_add_u32 s38, s38, -128
    v_bfe_u32 v60, v0, 3, 1
    v_lshlrev_b32 v60, 12, v60
    v_lshrrev_b32 v43, 4, v0
    v_lshl_add_u32 v60, v43, 9, v60
    v_bfe_u32 v43, v0, 2, 1
    v_lshl_add_u32 v60, v43, 7, v60
    v_and_b32 v43, 3, v0
    v_lshl_add_u32 v60, v43, 3, v60
    v_add_u32 v60, s38, v60
    ds_read_b64_tr_b16 v[96:97], v60 offset:0
    ds_read_b64_tr_b16 v[98:99], v60 offset:256
    ds_read_b64_tr_b16 v[100:101], v60 offset:2048
    ds_read_b64_tr_b16 v[102:103], v60 offset:2304
    ds_read_b64_tr_b16 v[104:105], v60 offset:8192
    ds_read_b64_tr_b16 v[106:107], v60 offset:8448
    ds_read_b64_tr_b16 v[108:109], v60 offset:10240
    ds_read_b64_tr_b16 v[110:111], v60 offset:10496
    ds_read_b64_tr_b16 v[112:113], v60 offset:16384
    ds_read_b64_tr_b16 v[114:115], v60 offset:16640
    ds_read_b64_tr_b16 v[116:117], v60 offset:18432
    ds_read_b64_tr_b16 v[118:119], v60 offset:18688
    v_mov_b32 v36, 0
    v_mov_b32 v37, 0
    v_mov_b32 v38, 0
    v_mov_b32 v39, 0
    v_mov_b32 v44, 0
    v_mov_b32 v45, 0
    v_mov_b32 v46, 0
    v_mov_b32 v47, 0
    v_mov_b32 v56, 0
    v_mov_b32 v57, 0
    v_mov_b32 v58, 0
    v_mov_b32 v59, 0
    s_and_b32 s39, s5, 3
    s_mul_i32 s38, s39, 1280
    s_add_u32 s38, s38, 15488
    v_lshl_add_u32 v41, v0, 4, s38
    v_lshrrev_b32 v42, 2, v0
    v_lshlrev_b32 v42, 4, v42
    v_add_u32 v42, s38, v42
    s_mul_i32 s38, s4, 81920
    s_mul_i32 s50, s5, 2560
    s_add_u32 s38, s38, s50
    s_lshl_b32 s50, s3, 8
    s_add_u32 s38, s38, s50
    s_add_u32 s38, s38, 294912
    v_lshl_add_u32 v43, v0, 2, s38
    s_waitcnt lgkmcnt(0)
    s_branch PG_57
.p2align 12,,352
PG_57:
    v_mov_b32 v62, 13312
    s_add_u32 s36, s46, 4294951808
    s_addc_u32 s37, s47, 0
    s_sub_u32 s37, s37, 1
    s_mov_b32 s43, 262144
    s_mov_b64 exec, 1
PL_58:
    global_load_dword v61, v62, s[36:37] sc1
    s_waitcnt vmcnt(0)
    v_cmp_eq_u32 vcc, -1, v61
    s_cbranch_vccz PK_59
    s_sleep 4
    s_sub_u32 s43, s43, 1
    s_cbranch_scc0 PL_58
PK_59:
    s_mov_b64 exec, -1
    s_sleep 14
    s_setprio 2
    global_load_dwordx4 v[120:123], v41, s[46:47] sc1
    global_load_dwordx4 v[124:127], v42, s[46:47] offset:1024 sc1
    s_mov_b32 s43, 262144
    s_nop 15
    s_nop 7
    global_load_dwordx4 v[120:123], v41, s[46:47] sc1
    global_load_dwordx4 v[124:127], v42, s[46:47] offset:1024 sc1
    s_branch PC_61
PM_60:
    s_mov_b64 exec, s[8:9]
    global_load_dwordx4 v[120:123], v41, s[46:47] sc1
    s_mov_b64 exec, s[10:11]
    global_load_dwordx4 v[124:127], v42, s[46:47] offset:1024 sc1
    s_mov_b64 exec, -1
    s_sub_u32 s43, s43, 1
    s_cbranch_scc1 PD_62
PC_61:
    s_waitcnt vmcnt(3)
    v_max3_u32 v60, v120, v121, v122
    v_max_u32 v60, v60, v123
    v_cmp_eq_u32 s[8:9], -1, v60
    s_waitcnt vmcnt(2)
    v_max3_u32 v60, v124, v125, v126
    v_max_u32 v60, v60, v127
    v_cmp_eq_u32 s[10:11], -1, v60
    s_nop 0
    s_or_b64 s[44:45], s[8:9], s[10:11]
    s_cbranch_scc1 PM_60
PD_62:
    v_smfmac_f32_16x16x64_bf16 v[36:39], v[120:123], v[96:103], v1
    v_smfmac_f32_16x16x64_bf16 v[44:47], v[120:123], v[104:111], v1
    v_smfmac_f32_16x16x64_bf16 v[56:59], v[124:127], v[112:119], v1
    s_cmp_eq_u32 s7, 0
    s_nop 4
    v_add_f32 v36, v36, v38
    v_add_f32 v45, v45, v47
    v_add_f32 v36, v36, v45
    v_add_f32 v36, v36, v56
    v_min_u32 v36, -2, v36
    s_cbranch_scc1 SG_63
    global_store_dword v43, v36, s[30:31]
    s_branch SE_64
SG_63:
    global_store_dword v43, v36, s[30:31] sc1
SE_64:
    s_setprio 0
    s_mov_b32 s6, 1
    s_branch L_BAR
L_POLLER:
    s_and_b32 s39, s5, 24
    s_mul_i32 s38, s4, 81920
    s_mul_i32 s50, s39, 2560
    s_add_u32 s38, s38, s50
    s_lshl_b32 s50, s57, 6
    s_add_u32 s38, s38, s50
    s_add_u32 s38, s38, 299776
    v_lshrrev_b32 v122, 5, v0
    v_mul_u32_u24 v122, 10240, v122
    v_bfe_u32 v125, v0, 3, 2
    v_lshl_add_u32 v122, v125, 8, v122
    v_and_b32 v125, 7, v0
    v_lshl_add_u32 v122, v125, 3, v122
    v_add_u32 v122, s38, v122
    v_lshrrev_b32 v124, 5, v0
    v_lshlrev_b32 v124, 7, v124
    v_bfe_u32 v125, v0, 3, 1
    v_lshl_add_u32 v124, v125, 6, v124
    v_and_b32 v125, 1, v0
    v_lshl_add_u32 v124, v125, 5, v124
    v_bfe_u32 v125, v0, 4, 1
    v_lshl_add_u32 v124, v125, 4, v124
    v_bfe_u32 v125, v0, 1, 2
    v_lshl_add_u32 v124, v125, 2, v124
    v_add_u32 v124, 117248, v124
    s_lshl_b32 s38, s57, 6
    s_add_u32 s38, s38, 15488
    v_lshrrev_b32 v96, 4, v0
    v_mul_u32_u24 v96, 1280, v96
    v_bfe_u32 v125, v0, 2, 2
    v_lshl_add_u32 v96, v125, 8, v96
    v_and_b32 v125, 3, v0
    v_lshl_add_u32 v96, v125, 4, v96
    v_add_u32 v96, s38, v96
    s_lshl_b32 s38, s57, 4
    s_add_u32 s38, s38, 16512
    v_lshrrev_b32 v97, 4, v0
    v_mul_u32_u24 v97, 1280, v97
    v_bfe_u32 v125, v0, 2, 2
    v_lshl_add_u32 v97, v125, 6, v97
    v_and_b32 v125, 3, v0
    v_lshl_add_u32 v97, v125, 2, v97
    v_add_u32 v97, s38, v97
    s_branch PG_65
.p2align 12,,1024
PG_65:
    s_cmp_lg_u32 s94, 0
    s_cbranch_scc1 L_W3E
    s_lshr_b32 s39, s5, 1
    s_and_b32 s49, s5, 1
    s_lshl_b32 s38, s39, 14
    s_lshl_b32 s50, s49, 12
    s_add_u32 s38, s38, s50
    s_lshl_b32 s50, s4, 8
    s_add_u32 s38, s38, s50
    s_add_u32 s38, s38, 327680
    v_lshrrev_b32 v98, 5, v0
    v_mul_u32_u24 v98, 163840, v98
    v_bfe_u32 v99, v0, 4, 1
    v_lshl_add_u32 v98, v99, 11, v98
    v_and_b32 v99, 15, v0
    v_lshl_add_u32 v98, v99, 4, v98
    v_add_u32 v98, s38, v98
    v_mov_b32 v44, -1
    v_mov_b32 v45, -1
    v_mov_b32 v46, -1
    v_mov_b32 v47, -1
    v_mov_b32 v99, 122640
    s_mov_b32 s43, 262144
L_W3P:
    s_sleep 1
    ds_read_b64 v[100:101], v99
    s_sub_u32 s43, s43, 1
    s_cbranch_scc1 L_W3G
    s_waitcnt lgkmcnt(0)
    v_max_u32 v100, v100, v101
    v_cmp_eq_u32 vcc, -1, v100
    s_cbranch_vccnz L_W3P
L_W3G:
.p2align 5
    global_store_dwordx4 v98, v[44:47], s[34:35] sc1
    global_store_dwordx4 v98, v[44:47], s[32:33] sc1
    s_waitcnt vmcnt(1)
    s_nop 3
    s_getreg_b32 s38, hwreg(HW_REG_IB_STS, 0, 4)
    s_cmp_eq_u32 s38, 0
    s_cselect_b32 s48, 8192, 0
    v_mov_b32 v100, s48
    s_waitcnt vmcnt(0)
    ds_write_b32 v99, v100 offset:12
L_W3E:
    v_mov_b32 v62, 13312
    s_add_u32 s36, s46, 4294951808
    s_addc_u32 s37, s47, 0
    s_sub_u32 s37, s37, 1
    s_mov_b32 s43, 262144
    s_mov_b64 exec, 1
PL_66:
    global_load_dword v61, v62, s[36:37] sc1
    s_waitcnt vmcnt(0)
    v_cmp_eq_u32 vcc, -1, v61
    s_cbranch_vccz PK_67
    s_sleep 4
    s_sub_u32 s43, s43, 1
    s_cbranch_scc0 PL_66
PK_67:
    s_mov_b64 exec, -1
    s_sleep 14
    global_load_dwordx4 v[104:107], v96, s[46:47] sc1
    global_load_dword v108, v97, s[46:47] sc1
    s_mov_b32 s43, 262144
    s_branch PC_69
PM_68:
    s_mov_b64 exec, s[8:9]
    global_load_dwordx4 v[104:107], v96, s[46:47] sc1
    s_mov_b64 exec, s[10:11]
    global_load_dword v108, v97, s[46:47] sc1
    s_mov_b64 exec, -1
    s_sub_u32 s43, s43, 1
    s_cbranch_scc1 PD_70
PC_69:
    s_waitcnt vmcnt(1)
    v_max3_u32 v125, v104, v105, v106
    v_max_u32 v125, v125, v107
    v_cmp_eq_u32 s[8:9], -1, v125
    s_waitcnt vmcnt(0)
    v_cmp_eq_u32 s[10:11], -1, v108
    s_nop 0
    s_or_b64 s[44:45], s[8:9], s[10:11]
    s_cbranch_scc1 PM_68
PD_70:
    v_dot2_f32_bf16 v120, v104, s54, 0
    v_dot2_f32_bf16 v121, v104, v104, 0
    v_dot2_f32_bf16 v120, v105, s54, v120
    v_dot2_f32_bf16 v121, v105, v105, v121
    v_dot2_f32_bf16 v120, v106, s54, v120
    v_dot2_f32_bf16 v121, v106, v106, v121
    v_dot2_f32_bf16 v120, v107, s54, v120
    v_dot2_f32_bf16 v121, v107, v107, v121
    v_dot2_f32_bf16 v120, v108, s54, v120
    v_dot2_f32_bf16 v121, v108, v108, v121
    s_nop 1
    v_add_f32_dpp v120, v120, v120 quad_perm:[1,0,3,2] row_mask:0xf bank_mask:0xf
    v_add_f32_dpp v121, v121, v121 quad_perm:[1,0,3,2] row_mask:0xf bank_mask:0xf
    s_nop 0
    v_add_f32_dpp v120, v120, v120 quad_perm:[2,3,0,1] row_mask:0xf bank_mask:0xf
    v_add_f32_dpp v121, v121, v121 quad_perm:[2,3,0,1] row_mask:0xf bank_mask:0xf
    s_nop 0
    v_add_f32_dpp v120, v120, v120 row_ror:4 row_mask:0xf bank_mask:0xf
    v_add_f32_dpp v121, v121, v121 row_ror:4 row_mask:0xf bank_mask:0xf
    s_nop 0
    v_add_f32_dpp v120, v120, v120 row_ror:8 row_mask:0xf bank_mask:0xf
    v_add_f32_dpp v121, v121, v121 row_ror:8 row_mask:0xf bank_mask:0xf
    v_mov_b32 v125, v120
    v_mov_b32 v126, v121
    s_nop 0
    v_permlane16_swap_b32 v120, v125
    v_permlane16_swap_b32 v121, v126
    v_add_f32 v120, v120, v125
    v_add_f32 v121, v121, v126
    v_mov_b32 v125, v120
    v_mov_b32 v126, v121
    s_nop 0
    v_permlane32_swap_b32 v120, v125
    v_permlane32_swap_b32 v121, v126
    v_add_f32 v120, v120, v125
    v_add_f32 v121, v121, v126
    v_mul_f32 v120, 0x3acccccd, v120
    v_mul_f32 v121, 0x3acccccd, v121
    v_fma_f32 v121, -v120, v120, v121
    v_max_f32 v121, 0, v121
    v_add_f32 v121, 0x3727c5ac, v121
    v_rsq_f32 v121, v121
    s_nop 0
    v_mul_f32 v125, v120, v121
    v_mul_f32 v108, -v125, v12
    v_mul_f32 v109, -v125, v13
    global_load_dwordx2 v[112:113], v122, s[30:31] offset:-3840 sc1
    global_load_dwordx2 v[114:115], v122, s[30:31] offset:-1280 sc1
    global_load_dwordx2 v[116:117], v122, s[30:31] offset:1280 sc1
    global_load_dwordx2 v[118:119], v122, s[30:31] offset:3840 sc1
    s_mov_b32 s43, 262144
    s_nop 15
    s_nop 7
    global_load_dwordx2 v[112:113], v122, s[30:31] offset:-3840 sc1
    global_load_dwordx2 v[114:115], v122, s[30:31] offset:-1280 sc1
    global_load_dwordx2 v[116:117], v122, s[30:31] offset:1280 sc1
    global_load_dwordx2 v[118:119], v122, s[30:31] offset:3840 sc1
    s_branch PC_72
PM_71:
    s_mov_b64 exec, s[8:9]
    global_load_dwordx2 v[112:113], v122, s[30:31] offset:-3840 sc1
    s_mov_b64 exec, s[10:11]
    global_load_dwordx2 v[114:115], v122, s[30:31] offset:-1280 sc1
    s_mov_b64 exec, s[12:13]
    global_load_dwordx2 v[116:117], v122, s[30:31] offset:1280 sc1
    s_mov_b64 exec, s[14:15]
    global_load_dwordx2 v[118:119], v122, s[30:31] offset:3840 sc1
    s_mov_b64 exec, -1
    s_sub_u32 s43, s43, 1
    s_cbranch_scc1 PD_73
PC_72:
    s_waitcnt vmcnt(7)
    v_max_u32 v125, v112, v113
    v_cmp_eq_u32 s[8:9], -1, v125
    s_waitcnt vmcnt(6)
    v_max_u32 v125, v114, v115
    v_cmp_eq_u32 s[10:11], -1, v125
    s_waitcnt vmcnt(5)
    v_max_u32 v125, v116, v117
    v_cmp_eq_u32 s[12:13], -1, v125
    s_or_b64 s[44:45], s[8:9], s[10:11]
    s_waitcnt vmcnt(4)
    v_max_u32 v125, v118, v119
    v_cmp_eq_u32 s[14:15], -1, v125
    s_or_b64 s[44:45], s[44:45], s[12:13]
    s_or_b64 s[44:45], s[44:45], s[14:15]
    s_cbranch_scc1 PM_71
PD_73:
    v_pk_add_f32 v[104:105], v[112:113], v[114:115]
    v_pk_add_f32 v[106:107], v[116:117], v[118:119]
    v_pk_fma_f32 v[104:105], v[104:105], v[120:121], v[108:109] op_sel:[0,1,0] op_sel_hi:[1,1,1]
    v_pk_fma_f32 v[104:105], v[106:107], v[120:121], v[104:105] op_sel:[0,1,0] op_sel_hi:[1,1,1]
    v_cvt_pk_bf16_f32 v104, v104, v105
    ds_write_b32 v124, v104
    s_mov_b32 s6, 1
    v_mov_b32 v63, s40
    s_mov_b32 exec_lo, 0x000f000f
    s_mov_b32 exec_hi, 0x000f000f
    s_waitcnt lgkmcnt(0)
    s_barrier
    s_branch L_BAR2
.p2align 12,,1376
PG_74:
L_W2:
    s_cmp_lg_u32 s94, 0
    s_cbranch_scc1 L_IDLE
    s_cmp_lg_u32 s6, 0
    s_cbranch_scc1 L_W2S
    s_lshl_b32 s38, s5, 6
    s_add_u32 s0, s0, s38
    s_addc_u32 s1, s1, 0
    v_mov_b32 v6, 122640
    s_mov_b32 s43, 262144
L_W2P:
    s_sleep 1
    ds_read_b64 v[8:9], v6
    s_sub_u32 s43, s43, 1
    s_cbranch_scc1 L_W2G
    s_waitcnt lgkmcnt(0)
    v_max_u32 v8, v8, v9
    v_cmp_eq_u32 vcc, -1, v8
    s_cbranch_vccnz L_W2P
L_W2G:
    s_sleep 2
    s_mov_b32 m0, 55296
    s_nop 0
    global_load_lds_dwordx4 v41, s[0:1]
    s_mov_b32 m0, 56320
    s_add_u32 s0, s0, 20480
    s_addc_u32 s1, s1, 0
    global_load_lds_dwordx4 v41, s[0:1]
    s_mov_b32 m0, 57472
    s_add_u32 s0, s0, 20480
    s_addc_u32 s1, s1, 0
    global_load_lds_dwordx4 v41, s[0:1]
    s_mov_b32 m0, 58496
    s_add_u32 s0, s0, 20480
    s_addc_u32 s1, s1, 0
    global_load_lds_dwordx4 v41, s[0:1]
    s_mov_b32 m0, 59648
    s_add_u32 s0, s0, 20480
    s_addc_u32 s1, s1, 0
    global_load_lds_dwordx4 v41, s[0:1]
    s_mov_b32 m0, 60672
    s_add_u32 s0, s0, 20480
    s_addc_u32 s1, s1, 0
    global_load_lds_dwordx4 v41, s[0:1]
    s_mov_b32 m0, 61824
    s_add_u32 s0, s0, 20480
    s_addc_u32 s1, s1, 0
    global_load_lds_dwordx4 v41, s[0:1]
    s_mov_b32 m0, 62848
    s_add_u32 s0, s0, 20480
    s_addc_u32 s1, s1, 0
    global_load_lds_dwordx4 v41, s[0:1]
    s_mov_b32 m0, 64000
    s_add_u32 s0, s0, 20480
    s_addc_u32 s1, s1, 0
    global_load_lds_dwordx4 v41, s[0:1]
    s_mov_b32 m0, 65024
    s_add_u32 s0, s0, 20480
    s_addc_u32 s1, s1, 0
    global_load_lds_dwordx4 v41, s[0:1]
    s_mov_b32 m0, 66176
    s_add_u32 s0, s0, 20480
    s_addc_u32 s1, s1, 0
    global_load_lds_dwordx4 v41, s[0:1]
    s_mov_b32 m0, 67200
    s_add_u32 s0, s0, 20480
    s_addc_u32 s1, s1, 0
    global_load_lds_dwordx4 v41, s[0:1]
    s_cmp_eq_u32 s92, 6
    s_cbranch_scc1 L_W2D
    s_mov_b32 m0, 68352
    s_add_u32 s0, s0, 20480
    s_addc_u32 s1, s1, 0
    global_load_lds_dwordx4 v41, s[0:1]
    s_mov_b32 m0, 69376
    s_add_u32 s0, s0, 20480
    s_addc_u32 s1, s1, 0
    global_load_lds_dwordx4 v41, s[0:1]
L_W2D:
    s_waitcnt vmcnt(0)
    ds_write_b32 v6, v6 offset:8
L_W2S:
    s_mov_b32 s38, 10240
    v_lshl_add_u32 v3, v0, 4, s38
    s_lshl_b32 s38, s6, 6
    s_add_u32 s38, s38, 122688
    v_lshl_add_u32 v4, v0, 2, s38
    v_mov_b32 v5, 8192
    s_mov_b32 s43, 262144
    s_mov_b64 exec, 1
PL_75:
    global_load_dword v6, v5, s[46:47] sc1
    s_waitcnt vmcnt(0)
    v_cmp_eq_u32 vcc, -1, v6
    s_cbranch_vccz PK_76
    s_sleep 4
    s_sub_u32 s43, s43, 1
    s_cbranch_scc0 PL_75
PK_76:
    s_mov_b64 exec, -1
    global_load_dwordx4 v[96:99], v3, s[46:47] offset:-2048 sc1
    global_load_dwordx4 v[100:103], v3, s[46:47] offset:-1024 sc1
    global_load_dwordx4 v[104:107], v3, s[46:47] offset:0 sc1
    global_load_dwordx4 v[108:111], v3, s[46:47] offset:1024 sc1
    global_load_dwordx4 v[112:115], v3, s[46:47] offset:2048 sc1
    s_mov_b32 s43, 262144
    s_branch PC_78
PM_77:
    s_sleep 3
    s_mov_b64 exec, s[8:9]
    global_load_dwordx4 v[96:99], v3, s[46:47] offset:-2048 sc1
    s_mov_b64 exec, s[10:11]
    global_load_dwordx4 v[100:103], v3, s[46:47] offset:-1024 sc1
    s_mov_b64 exec, s[12:13]
    global_load_dwordx4 v[104:107], v3, s[46:47] offset:0 sc1
    s_mov_b64 exec, s[14:15]
    global_load_dwordx4 v[108:111], v3, s[46:47] offset:1024 sc1
    s_mov_b64 exec, s[16:17]
    global_load_dwordx4 v[112:115], v3, s[46:47] offset:2048 sc1
    s_mov_b64 exec, -1
    s_sub_u32 s43, s43, 1
    s_cbranch_scc1 PD_79
PC_78:
    s_waitcnt vmcnt(4)
    v_max3_u32 v7, v96, v97, v98
    v_max_u32 v7, v7, v99
    v_cmp_eq_u32 s[8:9], -1, v7
    s_waitcnt vmcnt(3)
    v_max3_u32 v7, v100, v101, v102
    v_max_u32 v7, v7, v103
    v_cmp_eq_u32 s[10:11], -1, v7
    s_waitcnt vmcnt(2)
    v_max3_u32 v7, v104, v105, v106
    v_max_u32 v7, v7, v107
    v_cmp_eq_u32 s[12:13], -1, v7
    s_or_b64 s[44:45], s[8:9], s[10:11]
    s_waitcnt vmcnt(1)
    v_max3_u32 v7, v108, v109, v110
    v_max_u32 v7, v7, v111
    v_cmp_eq_u32 s[14:15], -1, v7
    s_or_b64 s[44:45], s[44:45], s[12:13]
    s_waitcnt vmcnt(0)
    v_max3_u32 v7, v112, v113, v114
    v_max_u32 v7, v7, v115
    v_cmp_eq_u32 s[16:17], -1, v7
    s_or_b64 s[44:45], s[44:45], s[14:15]
    s_or_b64 s[44:45], s[44:45], s[16:17]
    s_cbranch_scc1 PM_77
PD_79:
    v_dot2_f32_bf16 v9, v96, s54, 0
    v_dot2_f32_bf16 v8, v96, v96, 0
    v_dot2_f32_bf16 v9, v97, s54, v9
    v_dot2_f32_bf16 v8, v97, v97, v8
    v_dot2_f32_bf16 v9, v98, s54, v9
    v_dot2_f32_bf16 v8, v98, v98, v8
    v_dot2_f32_bf16 v9, v99, s54, v9
    v_dot2_f32_bf16 v8, v99, v99, v8
    v_dot2_f32_bf16 v9, v100, s54, v9
    v_dot2_f32_bf16 v8, v100, v100, v8
    v_dot2_f32_bf16 v9, v101, s54, v9
    v_dot2_f32_bf16 v8, v101, v101, v8
    v_dot2_f32_bf16 v9, v102, s54, v9
    v_dot2_f32_bf16 v8, v102, v102, v8
    v_dot2_f32_bf16 v9, v103, s54, v9
    v_dot2_f32_bf16 v8, v103, v103, v8
    v_dot2_f32_bf16 v9, v104, s54, v9
    v_dot2_f32_bf16 v8, v104, v104, v8
    v_dot2_f32_bf16 v9, v105, s54, v9
    v_dot2_f32_bf16 v8, v105, v105, v8
    v_dot2_f32_bf16 v9, v106, s54, v9
    v_dot2_f32_bf16 v8, v106, v106, v8
    v_dot2_f32_bf16 v9, v107, s54, v9
    v_dot2_f32_bf16 v8, v107, v107, v8
    v_dot2_f32_bf16 v9, v108, s54, v9
    v_dot2_f32_bf16 v8, v108, v108, v8
    v_dot2_f32_bf16 v9, v109, s54, v9
    v_dot2_f32_bf16 v8, v109, v109, v8
    v_dot2_f32_bf16 v9, v110, s54, v9
    v_dot2_f32_bf16 v8, v110, v110, v8
    v_dot2_f32_bf16 v9, v111, s54, v9
    v_dot2_f32_bf16 v8, v111, v111, v8
    v_dot2_f32_bf16 v9, v112, s54, v9
    v_dot2_f32_bf16 v8, v112, v112, v8
    v_dot2_f32_bf16 v9, v113, s54, v9
    v_dot2_f32_bf16 v8, v113, v113, v8
    v_dot2_f32_bf16 v9, v114, s54, v9
    v_dot2_f32_bf16 v8, v114, v114, v8
    v_dot2_f32_bf16 v9, v115, s54, v9
    v_dot2_f32_bf16 v8, v115, v115, v8
    s_nop 1
    v_add_f32_dpp v9, v9, v9 quad_perm:[1,0,3,2] row_mask:0xf bank_mask:0xf
    v_add_f32_dpp v8, v8, v8 quad_perm:[1,0,3,2] row_mask:0xf bank_mask:0xf
    s_nop 0
    v_add_f32_dpp v9, v9, v9 quad_perm:[2,3,0,1] row_mask:0xf bank_mask:0xf
    v_add_f32_dpp v8, v8, v8 quad_perm:[2,3,0,1] row_mask:0xf bank_mask:0xf
    v_mov_b32 v10, v9
    v_mov_b32 v7, v8
    s_nop 0
    v_permlane16_swap_b32 v9, v10
    v_permlane16_swap_b32 v8, v7
    v_add_f32 v9, v9, v10
    v_add_f32 v8, v8, v7
    v_mov_b32 v10, v9
    v_mov_b32 v7, v8
    s_nop 0
    v_permlane32_swap_b32 v9, v10
    v_permlane32_swap_b32 v8, v7
    v_add_f32 v9, v9, v10
    v_add_f32 v8, v8, v7
    v_mul_f32 v9, 0x3acccccd, v9
    v_mul_f32 v8, 0x3acccccd, v8
    v_fma_f32 v8, -v9, v9, v8
    v_max_f32 v8, 0, v8
    v_add_f32 v8, 0x3727c5ac, v8
    v_rcp_f32 v8, v8
    s_nop 0
    v_min_u32 v8, -2, v8
    s_mov_b64 exec, 0xffff
    ds_write_b32 v4, v8
    s_mov_b64 exec, -1
    s_branch L_IDLE
L_SLOW:
    s_cmp_lg_u32 s3, 2
    s_cbranch_scc1 L_SL1
    v_mov_b32 v44, -1
    v_mov_b32 v45, -1
    v_mov_b32 v46, -1
    v_mov_b32 v47, -1
    s_mul_i32 s38, s4, 36864
    s_mul_i32 s50, s5, 1152
    s_add_u32 s38, s38, s50
    v_lshl_add_u32 v60, v0, 4, s38
    global_store_dwordx4 v60, v[44:47], s[30:31] sc1
    s_mov_b64 exec, 0xff
    global_store_dwordx4 v60, v[44:47], s[30:31] offset:1024 sc1
    s_mov_b64 exec, -1
    s_mul_i32 s38, s4, 81920
    s_mul_i32 s50, s5, 2560
    s_add_u32 s38, s38, s50
    s_add_u32 s38, s38, 294912
    v_lshl_add_u32 v60, v0, 4, s38
    global_store_dwordx4 v60, v[44:47], s[30:31] sc1
    global_store_dwordx4 v60, v[44:47], s[30:31] offset:1024 sc1
    s_mov_b32 exec_hi, 0
    global_store_dwordx4 v60, v[44:47], s[30:31] offset:2048 sc1
    s_mov_b64 exec, -1
    s_waitcnt vmcnt(0)
L_SL1:
    s_barrier
    s_cmp_lt_u32 s3, 4
    s_cbranch_scc1 L_SL2
    s_mul_i32 s38, s4, 81920
    s_mul_i32 s50, s5, 2560
    s_add_u32 s38, s38, s50
    s_lshl_b32 s50, s3, 8
    s_add_u32 s38, s38, s50
    s_add_u32 s38, s38, 293888
    v_lshl_add_u32 v60, v0, 2, s38
    s_mul_i32 s38, s4, 81920
    s_mul_i32 s50, s5, 2560
    s_add_u32 s38, s38, s50
    s_lshl_b32 s50, s3, 7
    s_add_u32 s38, s38, s50
    s_add_u32 s38, s38, 296448
    v_lshl_add_u32 v61, v0, 2, s38
    global_store_dword v60, v41, s[30:31] sc1
    s_mov_b32 exec_hi, 0
    global_store_dword v61, v42, s[30:31] sc1
    s_mov_b64 exec, -1
L_SL2:
    s_cmp_lg_u32 s3, 2
    s_cbranch_scc1 L_SL3
    s_lshl_b32 s38, s4, 9
    s_lshl_b32 s50, s5, 4
    s_add_u32 s38, s38, s50
    s_add_u32 s38, s38, 950272
    v_lshl_add_u32 v60, v0, 2, s38
    v_mov_b32 v61, 0x100
    s_mov_b64 exec, 1
    global_store_dword v60, v61, s[30:31] sc1
    s_mov_b64 exec, -1
L_SL3:
    s_cmp_lg_u32 s3, 3
    s_cbranch_scc1 L_SL4
    s_lshl_b32 s38, s4, 9
    s_add_u32 s38, s38, 950272
    v_and_b32 v17, 31, v0
    v_lshl_add_u32 v17, v17, 4, s38
    s_mov_b32 s43, 262144
    s_mov_b32 s39, 0x100
L_SL5:
    global_load_dword v18, v17, s[30:31] sc1
    s_waitcnt vmcnt(0)
    v_cmp_ne_u32 vcc, s39, v18
    s_cbranch_vccz L_SL6
    s_sub_u32 s43, s43, 1
    s_cbranch_scc0 L_SL5
L_SL6:
    global_load_dwordx2 v[112:113], v122, s[30:31] offset:-3840 sc1
    global_load_dwordx2 v[114:115], v122, s[30:31] offset:-1280 sc1
    global_load_dwordx2 v[116:117], v122, s[30:31] offset:1280 sc1
    global_load_dwordx2 v[118:119], v122, s[30:31] offset:3840 sc1
    global_load_dwordx2 v[24:25], v123, s[30:31] offset:-3840 sc1
    global_load_dwordx2 v[26:27], v123, s[30:31] offset:-1280 sc1
    global_load_dwordx2 v[28:29], v123, s[30:31] offset:1280 sc1
    global_load_dwordx2 v[30:31], v123, s[30:31] offset:3840 sc1
    s_waitcnt vmcnt(0)
    s_mov_b32 s43, 262144
L_Q1S:
    v_max3_u32 v125, v24, v25, v26
    v_max3_u32 v125, v125, v27, v28
    v_max3_u32 v125, v125, v29, v30
    v_max3_u32 v125, v125, v31, v112
    v_max3_u32 v125, v125, v113, v114
    v_max3_u32 v125, v125, v115, v116
    v_max3_u32 v125, v125, v117, v118
    v_max_u32 v125, v125, v119
    v_cmp_eq_u32 vcc, -1, v125
    s_cbranch_vccz L_Q1_OKS
    global_load_dwordx2 v[112:113], v122, s[30:31] offset:-3840 sc1
    global_load_dwordx2 v[114:115], v122, s[30:31] offset:-1280 sc1
    global_load_dwordx2 v[116:117], v122, s[30:31] offset:1280 sc1
    global_load_dwordx2 v[118:119], v122, s[30:31] offset:3840 sc1
    global_load_dwordx2 v[24:25], v123, s[30:31] offset:-3840 sc1
    global_load_dwordx2 v[26:27], v123, s[30:31] offset:-1280 sc1
    global_load_dwordx2 v[28:29], v123, s[30:31] offset:1280 sc1
    global_load_dwordx2 v[30:31], v123, s[30:31] offset:3840 sc1
    s_waitcnt vmcnt(0)
    s_sub_u32 s43, s43, 1
    s_cbranch_scc0 L_Q1S
L_Q1_OKS:
    v_pk_add_f32 v[24:25], v[24:25], v[26:27]
    v_pk_add_f32 v[28:29], v[28:29], v[30:31]
    v_pk_add_f32 v[12:13], v[24:25], v[28:29]
    v_mul_f32 v125, v120, v121
    v_mul_f32 v28, -v125, v12
    v_mul_f32 v29, -v125, v13
    v_pk_add_f32 v[24:25], v[112:113], v[114:115]
    v_pk_add_f32 v[26:27], v[116:117], v[118:119]
    v_pk_fma_f32 v[24:25], v[24:25], v[120:121], v[28:29] op_sel:[0,1,0] op_sel_hi:[1,1,1]
    v_pk_fma_f32 v[24:25], v[26:27], v[120:121], v[24:25] op_sel:[0,1,0] op_sel_hi:[1,1,1]
    v_cvt_pk_bf16_f32 v24, v24, v25
    ds_write_b32 v124, v24
    s_waitcnt lgkmcnt(0)
L_SL4:
    s_barrier
    s_branch L_SLOW_RET
L_FIN:
L_END:
    s_endpgm
.section .rodata,"a"
.p2align 6
.amdhsa_kernel interleave_layers__sliding_block_cached__glu_gated_reglu__decode_kernel
  .amdhsa_next_free_vgpr 256
  .amdhsa_next_free_sgpr 102
  .amdhsa_accum_offset 256
  .amdhsa_group_segment_fixed_size 0
  .amdhsa_kernarg_size 96
  .amdhsa_user_sgpr_count 2
  .amdhsa_user_sgpr_kernarg_segment_ptr 1
  .amdhsa_system_sgpr_workgroup_id_x 1
  .amdhsa_float_denorm_mode_32 3
.end_amdhsa_kernel
```
